```python
import torch

def _softmax(x, axis=-1):
    return torch.softmax(x, dim=axis)
def _gelu(x):
    return torch.nn.functional.gelu(x, approximate="tanh")
def _silu(x):
    return torch.nn.functional.silu(x)
def _sigmoid(x):
    return torch.sigmoid(x)
def _layernorm(x, axis=-1, eps=1e-5):
    m = x.mean(dim=axis, keepdim=True)
    v = x.var(dim=axis, keepdim=True, unbiased=False)
    return (x - m) / torch.sqrt(v + eps)
def _scatter_add(tgt, idx, src, axis=0):
    return tgt.clone().index_add_(axis, idx, src)
def _segment_sum(src, seg, n):
    out = torch.zeros((n,) + src.shape[1:], dtype=src.dtype)
    return out.index_add_(0, seg, src)
def _pad(x, pw):
    flat = tuple(v for pair in reversed(pw) for v in pair)
    return torch.nn.functional.pad(x, flat)

kernel_name = 'gated_mix__mha_block__ssm_conv_h3__prompt'

def setup_inputs():

    _w = (lambda a: (lambda t: t.to(torch.bfloat16) if t.is_floating_point() else t)(torch.as_tensor(a)))
    def _A_setup():
        B, S, D, H = 1, 2048, 512, 32
        return {
            "x": _w((lambda *s: torch.randn(*s, dtype=torch.bfloat16) * 0.05)(B, S, D)),
            "wqkv": _w((lambda *s: torch.randn(*s, dtype=torch.bfloat16) * 0.8)(D, 3 * D)),
            "wo": _w((lambda *s: torch.randn(*s, dtype=torch.bfloat16) * 0.05)(D, D)),
        }
    _A_in = _A_setup()

    def _B_setup():
        B, S, D = 1, 2048, 512
        ks = 4
        return {
            "q": _w((lambda *s: torch.randn(*s, dtype=torch.bfloat16) * 0.05)(B, S, D)),
            "k": _w((lambda *s: torch.randn(*s, dtype=torch.bfloat16) * 0.4)(B, S, D)),
            "v": _w((lambda *s: torch.randn(*s, dtype=torch.bfloat16) * 0.4)(B, S, D)),
            "shift_k": _w((lambda *s: torch.randn(*s, dtype=torch.bfloat16) * 0.4)(D, ks) * 0.5),
            "ssm_k": _w((lambda *s: torch.randn(*s, dtype=torch.bfloat16) * 1.6)(D, S) * (1.0 / S ** 0.5)),
            "ssm_D": _w((lambda *s: torch.randn(*s, dtype=torch.bfloat16) * 0.4)(D)),
        }
    _B_in = _B_setup()

    return {
        "A_x": _A_in["x"],
        "A_wqkv": _A_in["wqkv"],
        "A_wo": _A_in["wo"],
        "B_q": _B_in["q"],
        "B_k": _B_in["k"],
        "B_v": _B_in["v"],
        "B_shift_k": _B_in["shift_k"],
        "B_ssm_k": _B_in["ssm_k"],
        "B_ssm_D": _B_in["ssm_D"],
        "gate_w": _w((lambda *s: torch.randn(*s, dtype=torch.bfloat16) * 0.05)(512) * 16.0),
    }

def reference(A_x, A_wqkv, A_wo, B_q, B_k, B_v, B_shift_k, B_ssm_k, B_ssm_D, gate_w):
    def _A_ref(x, wqkv, wo):
        B, S, D = x.shape
        H = 32
        Dh = D // H
        qkv = (lambda x, *d: x.permute(*d))((x @ wqkv).reshape(B, S, 3, H, Dh), 2, 0, 3, 1, 4)
        q, k, v = qkv[0], qkv[1], qkv[2]
        scores = torch.einsum("bhqd,bhkd->bhqk", q, k) * (Dh ** -0.5)
        p = _softmax(scores, axis=-1)
        o = torch.einsum("bhqk,bhkd->bhqd", p, v)
        return (lambda x, *d: x.permute(*d))(o, 0, 2, 1, 3).reshape(B, S, D) @ wo

    def _B_ref(q, k, v, shift_k, ssm_k, ssm_D):
        B, S, D = q.shape
        ks = shift_k.shape[-1]
        k_pad = _pad(k, ((0, 0), (ks - 1, 0), (0, 0)))
        k_shift = torch.zeros_like(k)
        for t in range(ks):
            k_shift = k_shift + k_pad[:, t:t + S, :] * shift_k[:, ks - 1 - t][None, None, :]
        kv = k_shift * v
        L = 2 * S
        kv_pad = _pad(kv, ((0, 0), (0, S), (0, 0)))
        kf_pad = _pad(ssm_k, ((0, 0), (0, S)))
        kv_f = (lambda x, axes=(-2,-1): torch.fft.rfft2(x.float(), dim=axes))(kv_pad[:, None, :, :], axes=(1, 2))
        kf_f = (lambda x, axes=(-2,-1): torch.fft.rfft2(x.float(), dim=axes))(kf_pad[:, None, :], axes=(1, 2))
        kf_f = (lambda x, *d: x.permute(*d))(kf_f, 1, 2, 0)
        y_f = kv_f * kf_f[None, :, :, :]
        y = (lambda x, s, axes=(-2,-1): torch.fft.irfft2(x, s=s, dim=axes).to(torch.bfloat16))(y_f, (1, L), axes=(1, 2))[:, 0, :S, :]
        y = y + kv * ssm_D[None, None, :]
        return q * y

    x = A_x
    g = _sigmoid((x * gate_w).sum(-1, keepdims=True))
    a = _A_ref(x, A_wqkv, A_wo)
    b = _B_ref(x, B_k, B_v, B_shift_k, B_ssm_k, B_ssm_D)
    return g * a + (1 - g) * b
```

```asm
; @launch grid=(256,1,1) block=(512,1,1) lds=162816
.amdgcn_target "amdgcn-amd-amdhsa--gfx950"
.text
.globl gated_mix__mha_block__ssm_conv_h3__prompt_kernel
.p2align 8
.type gated_mix__mha_block__ssm_conv_h3__prompt_kernel,@function
gated_mix__mha_block__ssm_conv_h3__prompt_kernel:
    s_cmp_ge_u32 s2, 256
    s_cbranch_scc1 K_end
    v_lshlrev_b32 v221, 7, v0
    v_min_u32 v221, K_end-A_pc, v221
    s_getpc_b64 s[80:81]
A_pc:
    global_load_dword v221, v221, s[80:81]
    s_load_dwordx8 s[4:11], s[0:1], 0
    s_load_dwordx16 s[12:27], s[0:1], 32
    s_load_dwordx2 s[28:29], s[0:1], 96
    v_lshrrev_b32 v1, 6, v0
    v_and_b32 v0, 63, v0
    s_and_b32 s31, s2, 7
    v_readfirstlane_b32 s30, v1
    s_lshr_b32 s56, s2, 3
    s_lshr_b32 s57, s31, 1
    s_lshl_b32 s57, s57, 2
    s_lshr_b32 s59, s56, 3
    s_add_u32 s57, s57, s59
    s_and_b32 s58, s31, 1
    s_lshl_b32 s58, s58, 3
    s_and_b32 s60, s56, 7
    s_add_u32 s58, s58, s60
    s_cmp_lt_u32 s30, 4
    s_cbranch_scc1 A_compute
    s_setprio 1
    s_sub_u32 s84, s30, 4
    s_lshl_b32 s80, s57, 7
    s_lshl_b32 s81, s84, 5
    s_add_u32 s80, s80, s81
    v_lshrrev_b32 v6, 3, v0
    v_add_u32 v6, s80, v6
    v_lshlrev_b32 v6, 10, v6
    v_and_b32 v7, 7, v0
    v_lshrrev_b32 v8, 4, v0
    v_xor_b32 v9, v7, v8
    v_lshl_add_u32 v16, v9, 4, v6
    v_xor_b32 v9, 4, v9
    v_lshl_add_u32 v17, v9, 4, v6
    v_add_u32 v17, 7168, v17
    v_add_u32 v18, 14336, v16
    v_add_u32 v19, 14336, v17
    s_lshl_b32 s81, s84, 4
    v_lshrrev_b32 v6, 2, v0
    v_add_u32 v6, s81, v6
    v_mul_u32_u24 v6, 3072, v6
    v_and_b32 v7, 3, v0
    v_lshl_add_u32 v6, v7, 4, v6
    s_lshl_b32 s81, s58, 6
    v_add_u32 v20, s81, v6
    s_lshl_b32 s92, s84, 12
    s_lshl_b32 s93, s84, 11
    s_add_u32 s93, s93, 15360
    s_lshl_b32 s94, s59, 1
    s_add_u32 s94, s94, s60
    s_add_u32 s94, s59, s60
    s_and_b32 s94, s94, 3
    s_mul_i32 s94, s94, 2
    s_waitcnt lgkmcnt(0)
    s_mov_b32 s36, s4
    s_mov_b32 s37, s5
    s_mov_b32 s38, 0x200000
    s_mov_b32 s39, 0x20000
    s_mov_b32 s40, s6
    s_mov_b32 s41, s7
    s_mov_b32 s42, 0x180000
    s_mov_b32 s43, 0x20000
    s_add_u32 s95, s94, 0
    s_and_b32 s95, s95, 7
    s_lshl_b32 s100, s95, 7
    s_add_u32 m0, s92, 0
    s_mul_i32 s95, s95, 196608
    buffer_load_dwordx4 v16, s[36:39], s100 offen offset:0 lds
    buffer_load_dwordx4 v17, s[36:39], s100 offen offset:1024 lds
    buffer_load_dwordx4 v18, s[36:39], s100 offen offset:2048 lds
    buffer_load_dwordx4 v19, s[36:39], s100 offen offset:3072 lds
    s_add_u32 m0, s93, 0
    s_nop 0
    buffer_load_dwordx4 v20, s[40:43], s95 offen offset:1024 lds
    buffer_load_dwordx4 v20, s[40:43], s95 offen offset:2048 lds
    s_add_u32 s95, s94, 1
    s_and_b32 s95, s95, 7
    s_lshl_b32 s100, s95, 7
    s_add_u32 m0, s92, 24576
    s_mul_i32 s95, s95, 196608
    buffer_load_dwordx4 v16, s[36:39], s100 offen offset:0 lds
    buffer_load_dwordx4 v17, s[36:39], s100 offen offset:1024 lds
    buffer_load_dwordx4 v18, s[36:39], s100 offen offset:2048 lds
    buffer_load_dwordx4 v19, s[36:39], s100 offen offset:3072 lds
    s_add_u32 m0, s93, 24576
    s_nop 0
    buffer_load_dwordx4 v20, s[40:43], s95 offen offset:1024 lds
    buffer_load_dwordx4 v20, s[40:43], s95 offen offset:2048 lds
    v_lshlrev_b32 v32, 2, v0
    v_add_u32 v32, 162560, v32
    v_mov_b32 v33, 0
    ds_write_b32 v32, v33
    s_mov_b32 s32, s28
    s_mov_b32 s33, s29
    s_mov_b32 s34, 0xe60000
    s_mov_b32 s35, 0x20000
    s_mov_b32 s52, s26
    s_mov_b32 s53, s27
    s_mov_b32 s54, 0x100
    s_mov_b32 s55, 0x20000
    s_and_b32 s63, s30, 1
    s_lshr_b32 s64, s30, 1
    s_lshl_b32 s61, s58, 1
    s_add_u32 s61, s61, s63
    s_lshl_b32 s62, s2, 8
    s_add_u32 s62, s62, 14745600
    s_lshl_b32 s66, s61, 16
    s_lshl_b32 s67, s63, 12
    s_add_u32 s67, s67, 145152
    s_cmp_eq_u32 s64, 0
    s_cselect_b32 s68, 2048, 0
    s_xor_b32 s69, s68, 2048
    s_add_u32 s68, s68, s67
    s_add_u32 s69, s69, s67
    v_lshlrev_b32 v3, 4, v0
    v_add_u32 v246, s68, v3
    v_add_u32 v247, s69, v3
    s_lshr_b32 s71, s57, 2
    s_add_u32 s71, s71, 1
    s_mul_i32 s71, s71, 1
    s_add_u32 s71, s71, s64
    s_and_b32 s79, s71, 3
    s_lshl_b32 s70, s79, 14
    s_add_u32 s70, s70, s66
    s_add_u32 s71, s70, 4194304
    s_add_u32 s70, s70, 2097152
    s_mov_b32 s72, 0xffff
    s_mov_b32 s73, 0xffff
    s_lshl_b32 s74, s60, 3
    s_lshr_b32 s75, s58, 3
    s_add_u32 s74, s74, s75
    s_lshl_b32 s75, s79, 1
    s_add_u32 s74, s74, s75
    s_lshl_b32 s74, s74, 8
    s_add_u32 s74, s74, 14745600
    s_lshl_b32 s75, s31, 2
    s_add_u32 s75, s75, s59
    s_mov_b32 s76, s60
    s_lshl_b32 s77, s63, 15
    s_lshl_b32 s78, s64, 13
    s_add_u32 s77, s77, s78
    s_lshl_b32 s78, s64, 17
    s_lshl_b32 s85, s76, 7
    s_add_u32 s78, s78, s85
    s_lshl_b32 s79, s63, 6
    s_add_u32 s78, s78, s79
    s_lshl_b32 s79, s30, 10
    s_add_u32 s79, s79, 65536
    v_and_b32 v6, 31, v0
    v_lshlrev_b32 v5, 2, v6
    v_lshrrev_b32 v7, 5, v0
    v_lshlrev_b32 v239, 10, v6
    v_lshl_add_u32 v239, v7, 4, v239
    v_and_b32 v6, 15, v0
    v_lshlrev_b32 v6, 4, v6
    v_lshl_add_u32 v4, v7, 8, v6
    v_mov_b32 v2, 0xdddd
    v_and_b32 v6, 3, v0
    v_lshlrev_b32 v243, 2, v6
    v_add_u32 v243, 162560, v243
    v_bfe_u32 v8, v0, 2, 2
    v_lshlrev_b32 v241, 14, v6
    v_and_b32 v222, 0x4000, v241
    v_lshl_add_u32 v8, v7, 2, v8
    v_lshlrev_b32 v8, 6, v8
    v_lshl_add_u32 v8, v6, 3, v8
    s_and_b32 s80, s64, 1
    v_bfe_u32 v232, v0, 4, 1
    v_xor_b32 v232, s80, v232
    v_lshl_add_u32 v8, v232, 5, v8
    s_lshr_b32 s80, s64, 1
    s_lshl_b32 s80, s80, 15
    s_and_b32 s81, s31, 1
    s_xor_b32 s81, s81, 1
    s_mul_i32 s81, s81, 2
    s_xor_b32 s81, s81, s64
    s_lshl_b32 s81, s81, 13
    s_add_u32 s80, s80, s81
    s_and_b32 s82, s76, 1
    s_lshl_b32 s82, s82, 12
    s_add_u32 s80, s80, s82
    v_add_u32 v232, s80, v8
    v_lshrrev_b32 v8, 2, v0
    v_lshlrev_b32 v8, 10, v8
    v_lshl_add_u32 v244, v6, 4, v8
    s_lshl_b32 s83, s75, 1
    s_add_u32 s83, s83, s63
    s_lshl_b32 s83, s83, 15
    s_add_u32 s81, s81, s83
    s_add_u32 s81, s81, 11010048
    s_add_u32 s67, s81, s82
    s_xor_b32 s82, s82, 4096
    s_add_u32 s68, s81, s82
    s_add_u32 s69, s83, s85
    s_lshl_b32 s80, s64, 5
    s_add_u32 s69, s69, s80
    s_lshl_b32 s80, s75, 6
    s_lshl_b32 s81, s30, 3
    s_add_u32 s80, s80, s81
    v_lshrrev_b32 v8, 3, v0
    v_add_u32 v8, s80, v8
    v_lshlrev_b32 v8, 10, v8
    v_lshrrev_b32 v7, 4, v0
    s_lshl_b32 s81, s63, 2
    v_xor_b32 v7, s81, v7
    v_and_b32 v6, 7, v0
    v_xor_b32 v7, v7, v6
    v_lshl_add_u32 v8, v7, 4, v8
    v_add_u32 v245, s85, v8
    v_lshlrev_b32 v254, 2, v6
    v_add_u32 v254, 162560, v254
    v_bfe_u32 v7, v0, 3, 1
    v_lshlrev_b32 v6, 11, v6
    v_lshl_add_u32 v240, v7, 8, v6
    s_lshr_b32 s80, s75, 1
    s_and_b32 s84, s80, 3
    s_lshl_b32 s84, s84, 6
    s_lshr_b32 s80, s80, 2
    s_lshl_b32 s80, s80, 1
    s_add_u32 s80, s80, s84
    s_lshl_b32 s80, s80, 8
    s_add_u32 s101, s80, 14745608
    s_add_u32 s81, s81, s64
    s_xor_b32 s80, s81, 0
    s_mul_i32 s80, s80, 6144
    s_add_u32 s80, s80, 110336
    v_add_u32 v233, s80, v3
    s_xor_b32 s80, s81, 1
    s_mul_i32 s80, s80, 6144
    s_add_u32 s80, s80, 110336
    v_add_u32 v234, s80, v3
    s_xor_b32 s80, s81, 2
    s_mul_i32 s80, s80, 6144
    s_add_u32 s80, s80, 112384
    v_add_u32 v235, s80, v3
    s_xor_b32 s80, s81, 3
    s_mul_i32 s80, s80, 6144
    s_add_u32 s80, s80, 114432
    v_add_u32 v236, s80, v3
    s_and_b32 s84, s30, 3
    s_mul_i32 s65, s84, 9152
    s_add_u32 s65, s65, 73728
    s_waitcnt vmcnt(6) lgkmcnt(0)
    s_barrier
    s_add_u32 s95, s94, 2
    s_and_b32 s95, s95, 7
    s_lshl_b32 s100, s95, 7
    s_add_u32 m0, s92, 49152
    s_mul_i32 s95, s95, 196608
    buffer_load_dwordx4 v16, s[36:39], s100 offen offset:0 lds
    buffer_load_dwordx4 v17, s[36:39], s100 offen offset:1024 lds
    buffer_load_dwordx4 v18, s[36:39], s100 offen offset:2048 lds
    buffer_load_dwordx4 v19, s[36:39], s100 offen offset:3072 lds
    s_add_u32 m0, s93, 49152
    s_nop 0
    buffer_load_dwordx4 v20, s[40:43], s95 offen offset:1024 lds
    buffer_load_dwordx4 v20, s[40:43], s95 offen offset:2048 lds
    s_add_u32 s80, s65, 4096
    v_add_u32 v237, s80, v3
    v_add_u32 v238, s80, v5
    s_lshl_b32 s80, s84, 2
    s_add_u32 s80, s80, 162560
    v_mov_b32 v242, s80
    v_mov_b32 v252, 162560
    v_mov_b32 v253, 1
    v_mov_b32 v223, 0
    v_mov_b32 v248, 0
    v_mov_b32 v249, 0
    v_mov_b32 v250, 0
    v_mov_b32 v251, 0
    s_mov_b32 s44, s8
    s_mov_b32 s45, s9
    s_mov_b32 s46, 0x80000
    s_mov_b32 s47, 0x20000
    s_lshl_b32 s91, s31, 6
    s_lshl_b32 s80, s56, 1
    s_add_u32 s91, s91, s80
    s_lshr_b32 s80, s84, 1
    s_add_u32 s91, s91, s80
    s_and_b32 s80, s91, -2
    s_lshl_b32 s80, s80, 1
    s_load_dword s89, s[20:21], s80
    v_and_b32 v32, 31, v0
    v_lshrrev_b32 v33, 5, v0
    v_and_b32 v34, 15, v0
    v_lshrrev_b32 v35, 4, v0
    v_and_b32 v36, 7, v0
    v_lshrrev_b32 v37, 3, v0
    v_min_u32 v38, 29, v32
    s_waitcnt vmcnt(6)
    s_barrier
    s_add_u32 s95, s94, 3
    s_and_b32 s95, s95, 7
    s_lshl_b32 s100, s95, 7
    s_add_u32 m0, s92, 0
    s_mul_i32 s95, s95, 196608
    buffer_load_dwordx4 v16, s[36:39], s100 offen offset:0 lds
    buffer_load_dwordx4 v17, s[36:39], s100 offen offset:1024 lds
    buffer_load_dwordx4 v18, s[36:39], s100 offen offset:2048 lds
    buffer_load_dwordx4 v19, s[36:39], s100 offen offset:3072 lds
    s_add_u32 m0, s93, 0
    s_nop 0
    buffer_load_dwordx4 v20, s[40:43], s95 offen offset:1024 lds
    buffer_load_dwordx4 v20, s[40:43], s95 offen offset:2048 lds
    v_lshlrev_b32 v38, 4, v38
    v_mul_u32_u24 v39, 4576, v33
    v_add3_u32 v30, v38, v39, s65
    s_mul_i32 s80, s84, 8704
    s_add_u32 s80, s80, 110336
    v_add_u32 v6, s80, v3
    v_add_u32 v7, s80, v5
    s_lshl_b32 s81, s63, 8
    v_lshlrev_b32 v38, 4, v35
    v_lshl_add_u32 v8, v34, 2, v38
    s_sub_u32 s80, s81, 60
    v_add_u32 v8, s80, v8
    v_add_u32 v9, 64, v8
    v_add_u32 v10, 512, v8
    v_add_u32 v11, 2, v3
    v_add_u32 v12, s65, v3
    s_xor_b32 s80, s84, 1
    s_lshl_b32 s82, s80, 2
    s_add_u32 s82, s82, 162560
    v_mov_b32 v14, s82
    s_mul_i32 s80, s80, 9152
    s_add_u32 s80, s80, 73728
    v_add_u32 v13, s80, v3
    v_and_b32 v39, 1, v0
    v_mul_u32_u24 v39, 4576, v39
    v_bfe_u32 v40, v0, 1, 3
    v_lshlrev_b32 v41, 6, v40
    v_sub_u32 v39, v39, v41
    s_add_u32 s80, s65, 448
    s_add_u32 s80, s80, s81
    v_add3_u32 v1, v39, v38, s80
    v_and_b32 v38, 3, v0
    v_lshlrev_b32 v29, 2, v38
    s_waitcnt vmcnt(6)
    s_barrier
    s_add_u32 s95, s94, 4
    s_and_b32 s95, s95, 7
    s_lshl_b32 s100, s95, 7
    s_add_u32 m0, s92, 24576
    s_mul_i32 s95, s95, 196608
    buffer_load_dwordx4 v16, s[36:39], s100 offen offset:0 lds
    buffer_load_dwordx4 v17, s[36:39], s100 offen offset:1024 lds
    buffer_load_dwordx4 v18, s[36:39], s100 offen offset:2048 lds
    buffer_load_dwordx4 v19, s[36:39], s100 offen offset:3072 lds
    s_add_u32 m0, s93, 24576
    s_nop 0
    buffer_load_dwordx4 v20, s[40:43], s95 offen offset:1024 lds
    buffer_load_dwordx4 v20, s[40:43], s95 offen offset:2048 lds
    v_lshlrev_b32 v38, 4, v38
    v_bfe_u32 v39, v0, 2, 2
    v_lshl_add_u32 v38, v39, 7, v38
    v_lshl_add_u32 v38, v33, 6, v38
    v_bfe_u32 v41, v0, 4, 1
    v_lshl_add_u32 v15, v41, 9, v38
    v_lshlrev_b32 v210, 9, v5
    v_lshlrev_b32 v211, 11, v36
    v_mul_u32_u24 v38, 4352, v37
    v_lshl_add_u32 v214, v36, 4, v38
    v_xor_b32 v42, v36, v35
    v_lshl_add_u32 v26, v42, 4, v38
    v_xor_b32 v42, 4, v42
    v_lshl_add_u32 v27, v42, 4, v38
    v_xor_b32 v38, v36, v37
    v_lshlrev_b32 v38, 4, v38
    v_lshl_add_u32 v38, v37, 7, v38
    s_add_u32 s80, s65, 6400
    v_add_u32 v215, s80, v38
    s_lshl_b32 s80, s63, 1
    v_lshl_add_u32 v38, v33, 2, s80
    v_xor_b32 v38, v38, v36
    v_lshlrev_b32 v38, 4, v38
    v_lshl_add_u32 v38, v34, 7, v38
    s_and_b32 s80, s64, 1
    s_mul_i32 s80, s80, 9152
    s_add_u32 s80, s80, 80128
    v_add_u32 v216, s80, v38
    s_lshl_b32 s80, s64, 1
    v_xor_b32 v38, s80, v40
    v_lshlrev_b32 v38, 4, v38
    v_lshl_add_u32 v38, v32, 7, v38
    v_lshl_add_u32 v38, v33, 3, v38
    s_waitcnt vmcnt(6)
    s_barrier
    s_add_u32 s95, s94, 5
    s_and_b32 s95, s95, 7
    s_lshl_b32 s100, s95, 7
    s_add_u32 m0, s92, 49152
    s_mul_i32 s95, s95, 196608
    buffer_load_dwordx4 v16, s[36:39], s100 offen offset:0 lds
    buffer_load_dwordx4 v17, s[36:39], s100 offen offset:1024 lds
    buffer_load_dwordx4 v18, s[36:39], s100 offen offset:2048 lds
    buffer_load_dwordx4 v19, s[36:39], s100 offen offset:3072 lds
    s_add_u32 m0, s93, 49152
    s_nop 0
    buffer_load_dwordx4 v20, s[40:43], s95 offen offset:1024 lds
    buffer_load_dwordx4 v20, s[40:43], s95 offen offset:2048 lds
    s_lshl_b32 s80, s63, 12
    s_add_u32 s80, s80, 65536
    v_add_u32 v217, s80, v38
    v_and_b32 v38, 1, v0
    v_lshl_or_b32 v39, v38, 2, v39
    v_xor_b32 v41, v41, v33
    v_lshl_or_b32 v39, v41, 3, v39
    v_bfe_u32 v38, v0, 1, 1
    v_lshlrev_b32 v38, 4, v38
    v_mov_b32 v41, 0x3f80
    v_lshlrev_b32 v38, v38, v41
    v_cmp_eq_u32 vcc, 0, v39
    s_nop 1
    v_cndmask_b32 v224, 0, v38, vcc
    v_cmp_eq_u32 vcc, 1, v39
    s_nop 1
    v_cndmask_b32 v225, 0, v38, vcc
    v_cmp_eq_u32 vcc, 2, v39
    s_nop 1
    v_cndmask_b32 v226, 0, v38, vcc
    v_cmp_eq_u32 vcc, 3, v39
    s_nop 1
    v_cndmask_b32 v227, 0, v38, vcc
    v_cmp_eq_u32 vcc, 4, v39
    s_nop 1
    v_cndmask_b32 v228, 0, v38, vcc
    v_cmp_eq_u32 vcc, 5, v39
    s_nop 1
    v_cndmask_b32 v229, 0, v38, vcc
    v_cmp_eq_u32 vcc, 6, v39
    s_nop 1
    v_cndmask_b32 v230, 0, v38, vcc
    v_cmp_eq_u32 vcc, 7, v39
    s_nop 1
    v_cndmask_b32 v231, 0, v38, vcc
    s_waitcnt vmcnt(6)
    s_barrier
    s_add_u32 s95, s94, 6
    s_and_b32 s95, s95, 7
    s_lshl_b32 s100, s95, 7
    s_add_u32 m0, s92, 0
    s_mul_i32 s95, s95, 196608
    buffer_load_dwordx4 v16, s[36:39], s100 offen offset:0 lds
    buffer_load_dwordx4 v17, s[36:39], s100 offen offset:1024 lds
    buffer_load_dwordx4 v18, s[36:39], s100 offen offset:2048 lds
    buffer_load_dwordx4 v19, s[36:39], s100 offen offset:3072 lds
    s_add_u32 m0, s93, 0
    s_nop 0
    buffer_load_dwordx4 v20, s[40:43], s95 offen offset:1024 lds
    buffer_load_dwordx4 v20, s[40:43], s95 offen offset:2048 lds
    s_lshl_b32 s80, s56, 16
    s_lshl_b32 s82, s84, 14
    s_add_u32 s80, s80, s82
    s_lshl_b32 s82, s31, 7
    s_add_u32 s80, s80, s82
    v_lshlrev_b32 v38, 13, v33
    v_lshl_add_u32 v38, v32, 2, v38
    v_add_u32 v22, s80, v38
    v_add_u32 v21, -3072, v22
    v_add_u32 v23, 4096, v22
    s_lshl_b32 s80, s31, 9
    v_lshl_add_u32 v28, v32, 4, s80
    s_lshl_b32 s80, s84, 1
    v_add_u32 v38, s80, v33
    v_sub_u32 v38, 7, v38
    v_xor_b32 v38, v38, v36
    v_lshlrev_b32 v38, 4, v38
    v_lshl_add_u32 v38, v32, 8, v38
    v_add_u32 v24, 153344, v38
    s_lshl_b32 s80, s84, 11
    s_add_u32 s80, s80, 153344
    v_add_u32 v25, s80, v3
    s_lshl_b32 s10, s31, 2
    s_add_u32 s10, s10, s84
    s_mul_i32 s10, s10, 69632
    s_lshl_b32 s80, s56, 7
    s_sub_u32 s10, s10, s80
    s_add_u32 s10, s10, 6295424
    s_add_u32 s11, s10, 34816
    s_lshl_b32 s87, s31, 8
    s_add_u32 s87, s87, 14745604
    s_waitcnt vmcnt(6)
    s_barrier
    s_add_u32 s95, s94, 7
    s_and_b32 s95, s95, 7
    s_lshl_b32 s100, s95, 7
    s_add_u32 m0, s92, 24576
    s_mul_i32 s95, s95, 196608
    buffer_load_dwordx4 v16, s[36:39], s100 offen offset:0 lds
    buffer_load_dwordx4 v17, s[36:39], s100 offen offset:1024 lds
    buffer_load_dwordx4 v18, s[36:39], s100 offen offset:2048 lds
    buffer_load_dwordx4 v19, s[36:39], s100 offen offset:3072 lds
    s_add_u32 m0, s93, 24576
    s_nop 0
    buffer_load_dwordx4 v20, s[40:43], s95 offen offset:1024 lds
    buffer_load_dwordx4 v20, s[40:43], s95 offen offset:2048 lds
    s_lshr_b32 s86, s31, 1
    s_lshl_b32 s86, s86, 1
    s_and_b32 s80, s75, 1
    s_add_u32 s86, s86, s80
    s_lshr_b32 s80, s75, 1
    s_and_b32 s80, s80, 3
    s_lshl_b32 s80, s80, 6
    s_add_u32 s86, s86, s80
    s_lshl_b32 s86, s86, 8
    s_add_u32 s86, s86, 14745604
    v_lshl_add_u32 v39, v35, 2, v34
    s_waitcnt lgkmcnt(0)
    s_and_b32 s80, s91, 1
    s_lshl_b32 s80, s80, 4
    s_lshr_b32 s89, s89, s80
    s_and_b32 s89, s89, 0xffff
    v_mov_b32 v38, s89
    v_cmp_eq_u32 vcc, 15, v39
    s_nop 1
    v_cndmask_b32 v218, 0, v38, vcc
    v_cmp_eq_u32 vcc, 14, v39
    s_nop 1
    v_cndmask_b32 v219, 0, v38, vcc
    v_cmp_eq_u32 vcc, 13, v39
    s_nop 1
    v_cndmask_b32 v220, 0, v38, vcc
    v_cmp_eq_u32 vcc, 12, v39
    s_nop 1
    v_cndmask_b32 v221, 0, v38, vcc
    v_and_b32 v38, 27, v0
    v_cmp_eq_u32 vcc, 16, v38
    v_mov_b32 v38, 0x3f803f80
    s_nop 0
    v_cndmask_b32 v38, 0, v38, vcc
    s_waitcnt vmcnt(6)
    s_barrier
    v_mov_b32 v176, v38
    v_mov_b32 v177, v38
    v_mov_b32 v178, v38
    v_mov_b32 v179, v38
    v_mov_b32 v180, v38
    v_mov_b32 v181, v38
    v_mov_b32 v182, v38
    v_mov_b32 v183, v38
    v_mov_b32 v184, v38
    v_mov_b32 v185, v38
    v_mov_b32 v186, v38
    v_mov_b32 v187, v38
    v_mov_b32 v188, v38
    v_mov_b32 v189, v38
    v_mov_b32 v190, v38
    v_mov_b32 v191, v38
    v_mov_b32 v192, v38
    v_mov_b32 v193, v38
    v_mov_b32 v194, v38
    v_mov_b32 v195, v38
    v_mov_b32 v196, v38
    v_mov_b32 v197, v38
    v_mov_b32 v198, v38
    v_mov_b32 v199, v38
    v_mov_b32 v200, v38
    v_mov_b32 v201, v38
    v_mov_b32 v202, v38
    v_mov_b32 v203, v38
    v_mov_b32 v204, v38
    v_mov_b32 v205, v38
    v_mov_b32 v206, v38
    v_mov_b32 v207, v38
    s_waitcnt vmcnt(0)
    s_barrier
    s_lshr_b32 s92, s92, 2
    s_add_u32 s95, s94, 0
    s_and_b32 s95, s95, 7
    s_add_u32 m0, s92, 110336
    s_mul_i32 s95, s95, 196608
    buffer_load_dwordx4 v20, s[40:43], s95 offen lds
    s_add_u32 s95, s94, 1
    s_and_b32 s95, s95, 7
    s_add_u32 m0, s92, 114432
    s_mul_i32 s95, s95, 196608
    buffer_load_dwordx4 v20, s[40:43], s95 offen lds
    s_add_u32 s95, s94, 2
    s_and_b32 s95, s95, 7
    s_add_u32 m0, s92, 118528
    s_mul_i32 s95, s95, 196608
    buffer_load_dwordx4 v20, s[40:43], s95 offen lds
    s_add_u32 s95, s94, 3
    s_and_b32 s95, s95, 7
    s_add_u32 m0, s92, 122624
    s_mul_i32 s95, s95, 196608
    buffer_load_dwordx4 v20, s[40:43], s95 offen lds
    s_barrier
    s_add_u32 s95, s94, 4
    s_and_b32 s95, s95, 7
    s_add_u32 m0, s92, 126720
    s_mul_i32 s95, s95, 196608
    buffer_load_dwordx4 v20, s[40:43], s95 offen lds
    s_add_u32 s95, s94, 5
    s_and_b32 s95, s95, 7
    s_add_u32 m0, s92, 130816
    s_mul_i32 s95, s95, 196608
    buffer_load_dwordx4 v20, s[40:43], s95 offen lds
    s_add_u32 s95, s94, 6
    s_and_b32 s95, s95, 7
    s_add_u32 m0, s92, 134912
    s_mul_i32 s95, s95, 196608
    buffer_load_dwordx4 v20, s[40:43], s95 offen lds
    s_add_u32 s95, s94, 7
    s_and_b32 s95, s95, 7
    s_add_u32 m0, s92, 139008
    s_mul_i32 s95, s95, 196608
    buffer_load_dwordx4 v20, s[40:43], s95 offen lds
    s_mov_b32 s40, s12
    s_mov_b32 s41, s13
    s_mov_b32 s42, 0x200000
    s_mov_b32 s43, 0x20000
    s_mov_b32 s48, s14
    s_mov_b32 s49, s15
    s_mov_b32 s50, 0x200000
    s_mov_b32 s51, 0x20000
    buffer_load_dword v32, v21, s[40:43], 0 offen offset:0 nt
    buffer_load_dword v33, v21, s[40:43], 0 offen offset:1024 nt
    buffer_load_dword v34, v21, s[40:43], 0 offen offset:2048 nt
    buffer_load_dword v35, v22, s[40:43], 0 offen offset:0 nt
    buffer_load_dword v36, v22, s[40:43], 0 offen offset:1024 nt
    buffer_load_dword v37, v22, s[40:43], 0 offen offset:2048 nt
    buffer_load_dword v38, v22, s[40:43], 0 offen offset:3072 nt
    buffer_load_dword v39, v23, s[40:43], 0 offen offset:0 nt
    buffer_load_dword v40, v23, s[40:43], 0 offen offset:1024 nt
    buffer_load_dword v41, v23, s[40:43], 0 offen offset:2048 nt
    buffer_load_dword v42, v23, s[40:43], 0 offen offset:3072 nt
    buffer_load_dword v43, v22, s[48:51], 0 offen offset:0 nt
    buffer_load_dword v44, v22, s[48:51], 0 offen offset:1024 nt
    buffer_load_dword v45, v22, s[48:51], 0 offen offset:2048 nt
    buffer_load_dword v46, v22, s[48:51], 0 offen offset:3072 nt
    buffer_load_dword v47, v23, s[48:51], 0 offen offset:0 nt
    buffer_load_dword v48, v23, s[48:51], 0 offen offset:1024 nt
    buffer_load_dword v49, v23, s[48:51], 0 offen offset:2048 nt
    buffer_load_dword v50, v23, s[48:51], 0 offen offset:3072 nt
    s_mov_b32 s40, s16
    s_mov_b32 s41, s17
    s_mov_b32 s42, 0x1000
    s_mov_b32 s43, 0x20000
    s_mov_b32 s48, s22
    s_mov_b32 s49, s23
    s_mov_b32 s50, 0x400
    s_mov_b32 s51, 0x20000
    s_lshl_b32 s12, s57, 7
    s_lshl_b32 s80, s58, 3
    s_add_u32 s12, s12, s80
    s_lshl_b32 s80, s84, 1
    s_add_u32 s12, s12, s80
    s_lshl_b32 s80, s12, 10
    s_lshl_b32 s12, s12, 2
    s_add_u32 s12, s12, 14680064
    buffer_load_dwordx4 v[52:55], v28, s[40:43], 0 offen
    buffer_load_dwordx4 v[152:155], v3, s[48:51], 0 offen
    buffer_load_dwordx4 v[144:147], v3, s[36:39], s80 offen
    buffer_load_dwordx4 v[148:151], v3, s[36:39], s80 offen offset:1024
    buffer_load_dword v56, v29, s[52:55], 0 offen sc1
    s_waitcnt vmcnt(24)
    s_barrier
    s_setprio 0
    ds_write_b128 v30, v[248:251] offset:4096
    s_mov_b32 s40, s24
    s_mov_b32 s41, s25
    s_mov_b32 s42, 0x200000
    s_mov_b32 s43, 0x20000
    s_mul_i32 s13, s91, 4352
    s_lshl_b32 s80, s63, 11
    s_add_u32 s7, s13, s80
    s_add_u32 s7, s7, 8650752
    s_add_u32 s13, s13, 6291456
    s_mov_b32 s88, s7
    s_add_u32 s89, s7, 1024
    s_and_b32 s4, s64, 1
    s_lshl_b32 s4, s4, 1
    s_lshl_b32 s5, s57, 2
    s_add_u32 s4, s4, s5
    s_lshl_b32 s4, s4, 15
    s_lshl_b32 s5, s61, 10
    s_add_u32 s4, s4, s5
    s_add_u32 s4, s4, 11010048
    s_add_u32 s5, s4, 0x8000
    s_mov_b32 s8, 1
    s_lshl_b32 s14, s75, 1
    s_add_u32 s14, s14, s63
    s_lshl_b32 s14, s14, 7
    s_add_u32 s14, s14, 14680064
    s_lshl_b32 s15, s76, 2
    s_add_u32 s15, s15, s84
    s_mul_i32 s15, s15, 69632
    s_lshl_b32 s82, s75, 7
    s_add_u32 s15, s15, s82
    s_add_u32 s15, s15, 8650752
    s_add_u32 s16, s15, 34816
    s_lshl_b32 s17, s76, 8
    s_add_u32 s17, s17, 14745608
    s_lshl_b32 s82, s91, 12
    s_add_u32 s82, s82, s80
    s_add_u32 s92, s18, s82
    s_addc_u32 s93, s19, 0
    s_mov_b32 s83, 99
    s_mov_b32 s82, 2
    s_mov_b32 s6, 0xffff0000
    s_waitcnt vmcnt(4)
    buffer_load_dword v57, v222, s[32:35], s74 offen sc1
    v_lshlrev_b32 v64, 16, v32
    v_and_b32 v65, s6, v32
    v_lshlrev_b32 v66, 16, v33
    v_and_b32 v67, s6, v33
    v_lshlrev_b32 v68, 16, v34
    v_and_b32 v69, s6, v34
    v_lshlrev_b32 v70, 16, v35
    v_and_b32 v71, s6, v35
    v_lshlrev_b32 v72, 16, v36
    v_and_b32 v73, s6, v36
    v_lshlrev_b32 v74, 16, v37
    v_and_b32 v75, s6, v37
    v_lshlrev_b32 v76, 16, v38
    v_and_b32 v77, s6, v38
    v_lshlrev_b32 v78, 16, v39
    v_and_b32 v79, s6, v39
    v_lshlrev_b32 v80, 16, v40
    v_and_b32 v81, s6, v40
    v_lshlrev_b32 v82, 16, v41
    v_and_b32 v83, s6, v41
    v_lshlrev_b32 v84, 16, v42
    v_and_b32 v85, s6, v42
    v_lshlrev_b32 v86, 16, v43
    v_and_b32 v87, s6, v43
    v_lshlrev_b32 v88, 16, v44
    v_and_b32 v89, s6, v44
    v_lshlrev_b32 v90, 16, v45
    v_and_b32 v91, s6, v45
    v_lshlrev_b32 v92, 16, v46
    v_and_b32 v93, s6, v46
    v_lshlrev_b32 v94, 16, v47
    v_and_b32 v95, s6, v47
    v_lshlrev_b32 v96, 16, v48
    v_and_b32 v97, s6, v48
    v_lshlrev_b32 v98, 16, v49
    v_and_b32 v99, s6, v49
    v_lshlrev_b32 v100, 16, v50
    v_and_b32 v101, s6, v50
    v_lshlrev_b32 v102, 16, v52
    v_and_b32 v104, s6, v52
    v_lshlrev_b32 v106, 16, v53
    v_and_b32 v108, s6, v53
    v_lshlrev_b32 v103, 16, v54
    v_and_b32 v105, s6, v54
    v_lshlrev_b32 v107, 16, v55
    v_and_b32 v109, s6, v55
    v_pk_mul_f32 v[110:111], v[64:65], v[108:109]
    v_pk_fma_f32 v[110:111], v[66:67], v[106:107], v[110:111]
    v_pk_fma_f32 v[110:111], v[68:69], v[104:105], v[110:111]
    v_pk_fma_f32 v[110:111], v[70:71], v[102:103], v[110:111]
    v_pk_mul_f32 v[110:111], v[110:111], v[86:87]
    v_pk_mul_f32 v[112:113], v[66:67], v[108:109]
    v_pk_fma_f32 v[112:113], v[68:69], v[106:107], v[112:113]
    v_pk_fma_f32 v[112:113], v[70:71], v[104:105], v[112:113]
    v_pk_fma_f32 v[112:113], v[72:73], v[102:103], v[112:113]
    v_pk_mul_f32 v[112:113], v[112:113], v[88:89]
    v_pk_mul_f32 v[114:115], v[68:69], v[108:109]
    v_pk_fma_f32 v[114:115], v[70:71], v[106:107], v[114:115]
    v_pk_fma_f32 v[114:115], v[72:73], v[104:105], v[114:115]
    v_pk_fma_f32 v[114:115], v[74:75], v[102:103], v[114:115]
    v_pk_mul_f32 v[114:115], v[114:115], v[90:91]
    v_pk_mul_f32 v[116:117], v[70:71], v[108:109]
    v_pk_fma_f32 v[116:117], v[72:73], v[106:107], v[116:117]
    v_pk_fma_f32 v[116:117], v[74:75], v[104:105], v[116:117]
    v_pk_fma_f32 v[116:117], v[76:77], v[102:103], v[116:117]
    v_pk_mul_f32 v[116:117], v[116:117], v[92:93]
    v_pk_mul_f32 v[118:119], v[72:73], v[108:109]
    v_pk_fma_f32 v[118:119], v[74:75], v[106:107], v[118:119]
    v_pk_fma_f32 v[118:119], v[76:77], v[104:105], v[118:119]
    v_pk_fma_f32 v[118:119], v[78:79], v[102:103], v[118:119]
    v_pk_mul_f32 v[118:119], v[118:119], v[94:95]
    v_pk_mul_f32 v[120:121], v[74:75], v[108:109]
    v_pk_fma_f32 v[120:121], v[76:77], v[106:107], v[120:121]
    v_pk_fma_f32 v[120:121], v[78:79], v[104:105], v[120:121]
    v_pk_fma_f32 v[120:121], v[80:81], v[102:103], v[120:121]
    v_pk_mul_f32 v[120:121], v[120:121], v[96:97]
    v_pk_mul_f32 v[122:123], v[76:77], v[108:109]
    v_pk_fma_f32 v[122:123], v[78:79], v[106:107], v[122:123]
    v_pk_fma_f32 v[122:123], v[80:81], v[104:105], v[122:123]
    v_pk_fma_f32 v[122:123], v[82:83], v[102:103], v[122:123]
    v_pk_mul_f32 v[122:123], v[122:123], v[98:99]
    v_pk_mul_f32 v[124:125], v[78:79], v[108:109]
    v_pk_fma_f32 v[124:125], v[80:81], v[106:107], v[124:125]
    v_pk_fma_f32 v[124:125], v[82:83], v[104:105], v[124:125]
    v_pk_fma_f32 v[124:125], v[84:85], v[102:103], v[124:125]
    v_pk_mul_f32 v[124:125], v[124:125], v[100:101]
    v_cvt_pk_bf16_f32 v32, v124, v122
    v_cvt_pk_bf16_f32 v33, v120, v118
    v_cvt_pk_bf16_f32 v34, v116, v114
    v_cvt_pk_bf16_f32 v35, v112, v110
    v_cvt_pk_bf16_f32 v36, v125, v123
    v_cvt_pk_bf16_f32 v37, v121, v119
    v_cvt_pk_bf16_f32 v38, v117, v115
    v_cvt_pk_bf16_f32 v39, v113, v111
    ds_write_b128 v24, v[32:35]
    ds_write_b128 v24, v[36:39] offset:128
    v_mov_b32 v48, 0
    v_mov_b32 v49, 0
    s_waitcnt vmcnt(0) lgkmcnt(0)
    ds_write_b32 v242, v253 offset:48
    v_dot2_f32_bf16 v48, v144, v152, v48
    v_dot2_f32_bf16 v49, v148, v152, v49
    v_dot2_f32_bf16 v48, v145, v153, v48
    v_dot2_f32_bf16 v49, v149, v153, v49
    v_dot2_f32_bf16 v48, v146, v154, v48
    v_dot2_f32_bf16 v49, v150, v154, v49
    v_dot2_f32_bf16 v48, v147, v155, v48
    v_dot2_f32_bf16 v49, v151, v155, v49
    s_nop 2
    v_add_f32_dpp v48, v48, v48 row_shr:1 row_mask:0xf bank_mask:0xf bound_ctrl:0
    v_add_f32_dpp v49, v49, v49 row_shr:1 row_mask:0xf bank_mask:0xf bound_ctrl:0
    s_nop 0
    v_add_f32_dpp v48, v48, v48 row_shr:2 row_mask:0xf bank_mask:0xf bound_ctrl:0
    v_add_f32_dpp v49, v49, v49 row_shr:2 row_mask:0xf bank_mask:0xf bound_ctrl:0
    s_nop 0
    v_add_f32_dpp v48, v48, v48 row_shr:4 row_mask:0xf bank_mask:0xf bound_ctrl:0
    v_add_f32_dpp v49, v49, v49 row_shr:4 row_mask:0xf bank_mask:0xf bound_ctrl:0
    s_nop 0
    v_add_f32_dpp v48, v48, v48 row_shr:8 row_mask:0xf bank_mask:0xf bound_ctrl:0
    v_add_f32_dpp v49, v49, v49 row_shr:8 row_mask:0xf bank_mask:0xf bound_ctrl:0
    s_nop 0
    v_add_f32_dpp v48, v48, v48 row_bcast:15 row_mask:0xa bank_mask:0xf
    v_add_f32_dpp v49, v49, v49 row_bcast:15 row_mask:0xa bank_mask:0xf
    s_nop 0
    v_add_f32_dpp v48, v48, v48 row_bcast:31 row_mask:0xc bank_mask:0xf
    v_add_f32_dpp v49, v49, v49 row_bcast:31 row_mask:0xc bank_mask:0xf
    s_nop 0
    v_cvt_pk_bf16_f32 v50, v48, v49
    v_lshlrev_b32 v48, 16, v50
    v_and_b32 v49, s6, v50
    v_mul_f32 v48, 0xbfb8aa3b, v48
    v_mul_f32 v49, 0xbfb8aa3b, v49
    v_exp_f32 v48, v48
    v_exp_f32 v49, v49
    s_nop 0
    v_add_f32 v48, 1.0, v48
    v_add_f32 v49, 1.0, v49
    v_rcp_f32 v48, v48
    v_rcp_f32 v49, v49
    s_nop 0
    v_cvt_pk_bf16_f32 v50, v48, v49
    v_lshlrev_b32 v136, 16, v50
    v_and_b32 v137, s6, v50
    v_mov_b32 v138, v26
    v_mov_b32 v139, v27
    v_cmp_eq_u32 vcc, 1, v56
    s_nop 0
    s_cmp_eq_u64 vcc, exec
    s_cbranch_scc0 AS1
AS1_ok:
    s_mov_b32 s90, 0x400000
LW3:
    ds_read_b32 v56, v243 offset:48
    s_waitcnt lgkmcnt(0)
    v_cmp_eq_u32 vcc, 1, v56
    s_sub_u32 s90, s90, 1
    s_cbranch_scc1 LW3_out
    s_cmp_eq_u64 vcc, exec
    s_cbranch_scc0 LW3
LW3_out:
    ds_read_b128 v[128:131], v25
    ds_read_b128 v[132:135], v25 offset:1024
    v_cmp_eq_u32 vcc, 1, v57
    s_nop 0
    s_cmp_eq_u64 vcc, exec
    s_cbranch_scc0 AS4
AS4_ok:
    buffer_load_dwordx4 v[160:163], v3, s[32:35], s70 offen offset:0 sc1
    s_mov_b64 exec, s[72:73]
    buffer_load_dwordx4 v[176:179], v4, s[32:35], s71 offen offset:0 sc1
    buffer_load_dwordx4 v[180:183], v4, s[32:35], s71 offen offset:512 sc1
    s_mov_b64 exec, -1
    buffer_load_dwordx4 v[164:167], v3, s[32:35], s70 offen offset:1024 sc1
    s_mov_b64 exec, s[72:73]
    buffer_load_dwordx4 v[184:187], v4, s[32:35], s71 offen offset:1024 sc1
    buffer_load_dwordx4 v[188:191], v4, s[32:35], s71 offen offset:1536 sc1
    s_mov_b64 exec, -1
    buffer_load_dwordx4 v[168:171], v3, s[32:35], s70 offen offset:2048 sc1
    s_mov_b64 exec, s[72:73]
    buffer_load_dwordx4 v[192:195], v4, s[32:35], s71 offen offset:2048 sc1
    buffer_load_dwordx4 v[196:199], v4, s[32:35], s71 offen offset:2560 sc1
    s_mov_b64 exec, -1
    buffer_load_dwordx4 v[172:175], v3, s[32:35], s70 offen offset:3072 sc1
    s_waitcnt lgkmcnt(0)
    buffer_store_dwordx4 v[128:131], v138, s[32:35], s10 offen sc1
    buffer_store_dwordx4 v[132:135], v139, s[32:35], s11 offen sc1
    s_mov_b32 exec_lo, 0
    s_mov_b32 exec_hi, 0x80000000
    buffer_store_dwordx2 v[136:137], v223, s[32:35], s12 offen sc1
    s_mov_b64 exec, -1
    s_mov_b32 s90, 0x400000
LW6:
    ds_read_b32 v16, v243 offset:16
    s_waitcnt lgkmcnt(0)
    v_cmp_eq_u32 vcc, 1, v16
    s_sub_u32 s90, s90, 1
    s_cbranch_scc1 LW6_out
    s_cmp_eq_u64 vcc, exec
    s_cbranch_scc0 LW6
LW6_out:
    ds_read_b128 v[16:19], v246 offset:0
    ds_read_b128 v[20:23], v246 offset:1024
    ds_read_b128 v[24:27], v247 offset:0
    ds_read_b128 v[28:31], v247 offset:1024
    s_mov_b32 s90, 0x400000
LW7:
    ds_read_b32 v56, v243 offset:80
    s_waitcnt lgkmcnt(0)
    v_cmp_eq_u32 vcc, 1, v56
    s_sub_u32 s90, s90, 1
    s_cbranch_scc1 LW7_out
    s_cmp_eq_u64 vcc, exec
    s_cbranch_scc0 LW7
LW7_out:
    s_setprio 1
    s_load_dword s100, s[92:93], 0
    s_load_dword s100, s[92:93], 128
    s_load_dword s100, s[92:93], 256
    s_load_dword s100, s[92:93], 384
    s_load_dword s100, s[92:93], 512
    s_load_dword s100, s[92:93], 640
    s_load_dword s100, s[92:93], 768
    s_load_dword s100, s[92:93], 896
    s_load_dword s100, s[92:93], 1024
    s_load_dword s100, s[92:93], 1152
    s_load_dword s100, s[92:93], 1280
    s_load_dword s100, s[92:93], 1408
    s_branch B_go
A_compute:
    v_and_b32 v20, 31, v0
    v_lshrrev_b32 v21, 5, v0
    v_bfe_u32 v22, v0, 1, 3
    v_xor_b32 v22, v22, v21
    s_lshl_b32 s80, s30, 12
    v_lshlrev_b32 v20, 7, v20
    v_lshl_add_u32 v20, v22, 4, v20
    v_add_u32 v6, s80, v20
    v_xor_b32 v7, 32, v6
    v_xor_b32 v8, 64, v6
    v_xor_b32 v9, 96, v6
    v_add_u32 v10, 49152, v6
    v_add_u32 v11, 49152, v7
    v_add_u32 v12, 49152, v8
    v_add_u32 v13, 49152, v9
    v_bfe_u32 v20, v0, 2, 2
    v_lshl_add_u32 v20, v21, 3, v20
    v_lshlrev_b32 v20, 6, v20
    v_bfe_u32 v22, v0, 4, 1
    v_lshl_add_u32 v20, v22, 5, v20
    v_and_b32 v23, 3, v0
    v_lshl_add_u32 v20, v23, 3, v20
    v_add_u32 v14, 16384, v20
    v_add_u32 v15, 65536, v20
    v_add_u32 v1, 110336, v20
    v_lshlrev_b32 v228, 2, v23
    v_mov_b32 v55, v22
    s_waitcnt lgkmcnt(0)
    s_mov_b32 s32, s28
    s_mov_b32 s33, s29
    s_mov_b32 s34, 0xe60000
    s_mov_b32 s35, 0x20000
    s_mov_b32 s52, s26
    s_mov_b32 s53, s27
    s_mov_b32 s54, 0x100
    s_mov_b32 s55, 0x20000
    s_cmp_lg_u32 s2, 0
    s_cbranch_scc1 A_noclear
    s_lshl_b32 s80, s30, 14
    s_add_u32 s80, s80, 14745600
    v_lshlrev_b32 v24, 8, v0
    v_mov_b32 v28, 0
    v_mov_b32 v29, 0
    v_mov_b32 v30, 0
    v_mov_b32 v31, 0
    v_mov_b32 v25, 1
    buffer_store_dwordx4 v[28:31], v24, s[32:35], s80 offen sc1
    s_lshl_b32 s80, s30, 2
    s_waitcnt vmcnt(0)
    s_mov_b64 exec, 1
    buffer_store_dword v25, v28, s[52:55], s80 offen sc1
    s_mov_b64 exec, -1
A_noclear:
    s_mov_b32 s36, s4
    s_mov_b32 s37, s5
    s_mov_b32 s38, 0x200000
    s_mov_b32 s39, 0x20000
    s_mov_b32 s40, s24
    s_mov_b32 s41, s25
    s_mov_b32 s42, 0x200000
    s_mov_b32 s43, 0x20000
    s_and_b32 s63, s30, 1
    s_lshr_b32 s64, s30, 1
    s_lshl_b32 s61, s58, 1
    s_add_u32 s61, s61, s63
    s_lshl_b32 s62, s2, 8
    s_add_u32 s62, s62, 14745600
    s_lshl_b32 s66, s61, 16
    s_lshl_b32 s67, s63, 12
    s_add_u32 s67, s67, 145152
    s_cmp_eq_u32 s64, 0
    s_cselect_b32 s68, 2048, 0
    s_xor_b32 s69, s68, 2048
    s_add_u32 s68, s68, s67
    s_add_u32 s69, s69, s67
    v_lshlrev_b32 v3, 4, v0
    v_add_u32 v246, s68, v3
    v_add_u32 v247, s69, v3
    s_lshr_b32 s71, s57, 2
    s_add_u32 s71, s71, 1
    s_mul_i32 s71, s71, 1
    s_add_u32 s71, s71, s64
    s_and_b32 s79, s71, 3
    s_lshl_b32 s70, s79, 14
    s_add_u32 s70, s70, s66
    s_add_u32 s71, s70, 4194304
    s_add_u32 s70, s70, 2097152
    s_mov_b32 s72, 0xffff
    s_mov_b32 s73, 0xffff
    s_lshl_b32 s74, s60, 3
    s_lshr_b32 s75, s58, 3
    s_add_u32 s74, s74, s75
    s_lshl_b32 s75, s79, 1
    s_add_u32 s74, s74, s75
    s_lshl_b32 s74, s74, 8
    s_add_u32 s74, s74, 14745600
    s_lshl_b32 s75, s31, 2
    s_add_u32 s75, s75, s59
    s_mov_b32 s76, s60
    s_lshl_b32 s77, s63, 15
    s_lshl_b32 s78, s64, 13
    s_add_u32 s77, s77, s78
    s_lshl_b32 s78, s64, 17
    s_lshl_b32 s85, s76, 7
    s_add_u32 s78, s78, s85
    s_lshl_b32 s79, s63, 6
    s_add_u32 s78, s78, s79
    s_lshl_b32 s79, s30, 10
    s_add_u32 s79, s79, 65536
    v_and_b32 v52, 31, v0
    v_lshlrev_b32 v5, 2, v52
    v_lshrrev_b32 v53, 5, v0
    v_lshlrev_b32 v239, 10, v52
    v_lshl_add_u32 v239, v53, 4, v239
    v_and_b32 v52, 15, v0
    v_lshlrev_b32 v52, 4, v52
    v_lshl_add_u32 v4, v53, 8, v52
    v_mov_b32 v2, 0xdddd
    v_and_b32 v52, 3, v0
    v_lshlrev_b32 v243, 2, v52
    v_add_u32 v243, 162560, v243
    v_bfe_u32 v54, v0, 2, 2
    v_lshlrev_b32 v241, 14, v52
    v_and_b32 v222, 0x4000, v241
    v_lshl_add_u32 v54, v53, 2, v54
    v_lshlrev_b32 v54, 6, v54
    v_lshl_add_u32 v54, v52, 3, v54
    s_and_b32 s80, s64, 1
    v_bfe_u32 v232, v0, 4, 1
    v_xor_b32 v232, s80, v232
    v_lshl_add_u32 v54, v232, 5, v54
    s_lshr_b32 s80, s64, 1
    s_lshl_b32 s80, s80, 15
    s_and_b32 s81, s31, 1
    s_xor_b32 s81, s81, 1
    s_mul_i32 s81, s81, 2
    s_xor_b32 s81, s81, s64
    s_lshl_b32 s81, s81, 13
    s_add_u32 s80, s80, s81
    s_and_b32 s82, s76, 1
    s_lshl_b32 s82, s82, 12
    s_add_u32 s80, s80, s82
    v_add_u32 v232, s80, v54
    v_lshrrev_b32 v54, 2, v0
    v_lshlrev_b32 v54, 10, v54
    v_lshl_add_u32 v244, v52, 4, v54
    s_lshl_b32 s83, s75, 1
    s_add_u32 s83, s83, s63
    s_lshl_b32 s83, s83, 15
    s_add_u32 s81, s81, s83
    s_add_u32 s81, s81, 11010048
    s_add_u32 s67, s81, s82
    s_xor_b32 s82, s82, 4096
    s_add_u32 s68, s81, s82
    s_add_u32 s69, s83, s85
    s_lshl_b32 s80, s64, 5
    s_add_u32 s69, s69, s80
    s_lshl_b32 s80, s75, 6
    s_lshl_b32 s81, s30, 3
    s_add_u32 s80, s80, s81
    v_lshrrev_b32 v54, 3, v0
    v_add_u32 v54, s80, v54
    v_lshlrev_b32 v54, 10, v54
    v_lshrrev_b32 v53, 4, v0
    s_lshl_b32 s81, s63, 2
    v_xor_b32 v53, s81, v53
    v_and_b32 v52, 7, v0
    v_xor_b32 v53, v53, v52
    v_lshl_add_u32 v54, v53, 4, v54
    v_add_u32 v245, s85, v54
    v_lshlrev_b32 v254, 2, v52
    v_add_u32 v254, 162560, v254
    v_bfe_u32 v53, v0, 3, 1
    v_lshlrev_b32 v52, 11, v52
    v_lshl_add_u32 v240, v53, 8, v52
    s_lshr_b32 s80, s75, 1
    s_and_b32 s84, s80, 3
    s_lshl_b32 s84, s84, 6
    s_lshr_b32 s80, s80, 2
    s_lshl_b32 s80, s80, 1
    s_add_u32 s80, s80, s84
    s_lshl_b32 s80, s80, 8
    s_add_u32 s101, s80, 14745608
    s_add_u32 s81, s81, s64
    s_xor_b32 s80, s81, 0
    s_mul_i32 s80, s80, 6144
    s_add_u32 s80, s80, 110336
    v_add_u32 v233, s80, v3
    s_xor_b32 s80, s81, 1
    s_mul_i32 s80, s80, 6144
    s_add_u32 s80, s80, 110336
    v_add_u32 v234, s80, v3
    s_xor_b32 s80, s81, 2
    s_mul_i32 s80, s80, 6144
    s_add_u32 s80, s80, 112384
    v_add_u32 v235, s80, v3
    s_xor_b32 s80, s81, 3
    s_mul_i32 s80, s80, 6144
    s_add_u32 s80, s80, 114432
    v_add_u32 v236, s80, v3
    s_and_b32 s84, s30, 3
    s_mul_i32 s65, s84, 9152
    s_add_u32 s65, s65, 73728
    s_barrier
    ds_read_b128 v[64:67], v6 offset:0
    ds_read_b64_tr_b16 v[192:193], v14 offset:0
    ds_read_b64_tr_b16 v[194:195], v14 offset:256
    ds_read_b64_tr_b16 v[196:197], v14 offset:1024
    ds_read_b64_tr_b16 v[198:199], v14 offset:1280
    ds_read_b128 v[68:71], v7 offset:0
    ds_read_b64_tr_b16 v[200:201], v14 offset:2048
    ds_read_b64_tr_b16 v[202:203], v14 offset:2304
    ds_read_b64_tr_b16 v[204:205], v14 offset:3072
    ds_read_b64_tr_b16 v[206:207], v14 offset:3328
    s_waitcnt lgkmcnt(5)
    v_mfma_f32_32x32x16_bf16 v[20:35], v[192:195], v[64:67], 0
    ds_read_b128 v[72:75], v8 offset:0
    ds_read_b64_tr_b16 v[208:209], v14 offset:4096
    ds_read_b64_tr_b16 v[210:211], v14 offset:4352
    v_mfma_f32_32x32x16_bf16 v[36:51], v[64:67], v[196:199], 0
    ds_read_b64_tr_b16 v[212:213], v14 offset:5120
    ds_read_b64_tr_b16 v[214:215], v14 offset:5376
    s_add_u32 s80, s65, 4096
    v_add_u32 v237, s80, v3
    s_waitcnt lgkmcnt(5)
    v_mfma_f32_32x32x16_bf16 v[20:35], v[200:203], v[68:71], v[20:35]
    ds_read_b128 v[76:79], v9 offset:0
    ds_read_b64_tr_b16 v[192:193], v14 offset:6144
    ds_read_b64_tr_b16 v[194:195], v14 offset:6400
    v_mfma_f32_32x32x16_bf16 v[36:51], v[68:71], v[204:207], v[36:51]
    ds_read_b64_tr_b16 v[196:197], v14 offset:7168
    ds_read_b64_tr_b16 v[198:199], v14 offset:7424
    v_add_u32 v238, s80, v5
    s_lshl_b32 s80, s84, 2
    s_waitcnt lgkmcnt(0)
    s_barrier
    v_mfma_f32_32x32x16_bf16 v[20:35], v[208:211], v[72:75], v[20:35]
    ds_read_b128 v[80:83], v6 offset:24576
    ds_read_b64_tr_b16 v[200:201], v14 offset:24576
    ds_read_b64_tr_b16 v[202:203], v14 offset:24832
    v_mfma_f32_32x32x16_bf16 v[36:51], v[72:75], v[212:215], v[36:51]
    ds_read_b64_tr_b16 v[204:205], v14 offset:25600
    ds_read_b64_tr_b16 v[206:207], v14 offset:25856
    s_add_u32 s80, s80, 162560
    v_mov_b32 v242, s80
    s_waitcnt lgkmcnt(5)
    v_mfma_f32_32x32x16_bf16 v[20:35], v[192:195], v[76:79], v[20:35]
    ds_read_b128 v[84:87], v7 offset:24576
    ds_read_b64_tr_b16 v[208:209], v14 offset:26624
    ds_read_b64_tr_b16 v[210:211], v14 offset:26880
    v_mfma_f32_32x32x16_bf16 v[36:51], v[76:79], v[196:199], v[36:51]
    ds_read_b64_tr_b16 v[212:213], v14 offset:27648
    ds_read_b64_tr_b16 v[214:215], v14 offset:27904
    v_mov_b32 v252, 162560
    v_mov_b32 v253, 1
    s_waitcnt lgkmcnt(5)
    v_mfma_f32_32x32x16_bf16 v[20:35], v[200:203], v[80:83], v[20:35]
    ds_read_b128 v[88:91], v8 offset:24576
    ds_read_b64_tr_b16 v[192:193], v14 offset:28672
    ds_read_b64_tr_b16 v[194:195], v14 offset:28928
    v_mfma_f32_32x32x16_bf16 v[36:51], v[80:83], v[204:207], v[36:51]
    ds_read_b64_tr_b16 v[196:197], v14 offset:29696
    ds_read_b64_tr_b16 v[198:199], v14 offset:29952
    v_mov_b32 v223, 0
    v_mov_b32 v248, 0
    v_mov_b32 v249, 0
    s_waitcnt lgkmcnt(5)
    v_mfma_f32_32x32x16_bf16 v[20:35], v[208:211], v[84:87], v[20:35]
    ds_read_b128 v[92:95], v9 offset:24576
    ds_read_b64_tr_b16 v[200:201], v14 offset:30720
    ds_read_b64_tr_b16 v[202:203], v14 offset:30976
    v_mfma_f32_32x32x16_bf16 v[36:51], v[84:87], v[212:215], v[36:51]
    ds_read_b64_tr_b16 v[204:205], v14 offset:31744
    ds_read_b64_tr_b16 v[206:207], v14 offset:32000
    v_mov_b32 v250, 0
    v_mov_b32 v251, 0
    s_waitcnt lgkmcnt(0)
    s_barrier
    v_mfma_f32_32x32x16_bf16 v[20:35], v[192:195], v[88:91], v[20:35]
    ds_read_b128 v[96:99], v10 offset:0
    ds_read_b64_tr_b16 v[208:209], v15 offset:0
    ds_read_b64_tr_b16 v[210:211], v15 offset:256
    v_mfma_f32_32x32x16_bf16 v[36:51], v[88:91], v[196:199], v[36:51]
    ds_read_b64_tr_b16 v[212:213], v15 offset:1024
    ds_read_b64_tr_b16 v[214:215], v15 offset:1280
    s_mov_b32 s44, s8
    s_mov_b32 s45, s9
    s_waitcnt lgkmcnt(5)
    v_mfma_f32_32x32x16_bf16 v[20:35], v[200:203], v[92:95], v[20:35]
    ds_read_b128 v[100:103], v11 offset:0
    ds_read_b64_tr_b16 v[192:193], v15 offset:2048
    ds_read_b64_tr_b16 v[194:195], v15 offset:2304
    v_mfma_f32_32x32x16_bf16 v[36:51], v[92:95], v[204:207], v[36:51]
    ds_read_b64_tr_b16 v[196:197], v15 offset:3072
    ds_read_b64_tr_b16 v[198:199], v15 offset:3328
    s_mov_b32 s46, 0x80000
    s_mov_b32 s47, 0x20000
    s_waitcnt lgkmcnt(5)
    v_mfma_f32_32x32x16_bf16 v[20:35], v[208:211], v[96:99], v[20:35]
    ds_read_b128 v[104:107], v12 offset:0
    ds_read_b64_tr_b16 v[200:201], v15 offset:4096
    ds_read_b64_tr_b16 v[202:203], v15 offset:4352
    v_mfma_f32_32x32x16_bf16 v[36:51], v[96:99], v[212:215], v[36:51]
    ds_read_b64_tr_b16 v[204:205], v15 offset:5120
    ds_read_b64_tr_b16 v[206:207], v15 offset:5376
    v_and_b32 v16, 0x33, v0
    v_bfe_u32 v17, v0, 2, 1
    s_waitcnt lgkmcnt(5)
    v_mfma_f32_32x32x16_bf16 v[20:35], v[192:195], v[100:103], v[20:35]
    ds_read_b128 v[108:111], v13 offset:0
    ds_read_b64_tr_b16 v[208:209], v15 offset:6144
    ds_read_b64_tr_b16 v[210:211], v15 offset:6400
    v_mfma_f32_32x32x16_bf16 v[36:51], v[100:103], v[196:199], v[36:51]
    ds_read_b64_tr_b16 v[212:213], v15 offset:7168
    ds_read_b64_tr_b16 v[214:215], v15 offset:7424
    v_lshl_or_b32 v16, v17, 3, v16
    v_bfe_u32 v17, v0, 3, 1
    v_lshl_or_b32 v16, v17, 2, v16
    s_waitcnt lgkmcnt(0)
    s_barrier
    v_mfma_f32_32x32x16_bf16 v[20:35], v[200:203], v[104:107], v[20:35]
    ds_read_b128 v[112:115], v6 offset:0
    ds_read_b64_tr_b16 v[192:193], v14 offset:0
    ds_read_b64_tr_b16 v[194:195], v14 offset:256
    v_mfma_f32_32x32x16_bf16 v[36:51], v[104:107], v[204:207], v[36:51]
    ds_read_b64_tr_b16 v[196:197], v14 offset:1024
    ds_read_b64_tr_b16 v[198:199], v14 offset:1280
    v_lshlrev_b32 v16, 4, v16
    v_lshl_add_u32 v17, v55, 16, v4
    s_waitcnt lgkmcnt(5)
    v_mfma_f32_32x32x16_bf16 v[20:35], v[208:211], v[108:111], v[20:35]
    ds_read_b128 v[116:119], v7 offset:0
    ds_read_b64_tr_b16 v[200:201], v14 offset:2048
    ds_read_b64_tr_b16 v[202:203], v14 offset:2304
    v_mfma_f32_32x32x16_bf16 v[36:51], v[108:111], v[212:215], v[36:51]
    ds_read_b64_tr_b16 v[204:205], v14 offset:3072
    ds_read_b64_tr_b16 v[206:207], v14 offset:3328
    s_lshl_b32 s80, s30, 10
    s_add_u32 s80, s80, 145152
    s_waitcnt lgkmcnt(5)
    v_mfma_f32_32x32x16_bf16 v[20:35], v[192:195], v[112:115], v[20:35]
    ds_read_b128 v[120:123], v8 offset:0
    ds_read_b64_tr_b16 v[208:209], v14 offset:4096
    ds_read_b64_tr_b16 v[210:211], v14 offset:4352
    v_mfma_f32_32x32x16_bf16 v[36:51], v[112:115], v[196:199], v[36:51]
    ds_read_b64_tr_b16 v[212:213], v14 offset:5120
    ds_read_b64_tr_b16 v[214:215], v14 offset:5376
    v_add_u32 v18, s80, v3
    s_lshl_b32 s10, s58, 17
    s_waitcnt lgkmcnt(5)
    v_mfma_f32_32x32x16_bf16 v[20:35], v[200:203], v[116:119], v[20:35]
    ds_read_b128 v[124:127], v9 offset:0
    ds_read_b64_tr_b16 v[192:193], v14 offset:6144
    ds_read_b64_tr_b16 v[194:195], v14 offset:6400
    v_mfma_f32_32x32x16_bf16 v[36:51], v[116:119], v[204:207], v[36:51]
    ds_read_b64_tr_b16 v[196:197], v14 offset:7168
    ds_read_b64_tr_b16 v[198:199], v14 offset:7424
    s_lshl_b32 s80, s57, 2
    s_add_u32 s81, s80, s30
    s_lshl_b32 s81, s81, 10
    s_waitcnt lgkmcnt(0)
    s_barrier
    v_mfma_f32_32x32x16_bf16 v[20:35], v[208:211], v[120:123], v[20:35]
    ds_read_b128 v[128:131], v6 offset:24576
    ds_read_b64_tr_b16 v[200:201], v14 offset:24576
    ds_read_b64_tr_b16 v[202:203], v14 offset:24832
    v_mfma_f32_32x32x16_bf16 v[36:51], v[120:123], v[212:215], v[36:51]
    ds_read_b64_tr_b16 v[204:205], v14 offset:25600
    ds_read_b64_tr_b16 v[206:207], v14 offset:25856
    s_add_u32 s10, s10, s81
    s_add_u32 s12, s10, 4194304
    s_waitcnt lgkmcnt(5)
    v_mfma_f32_32x32x16_bf16 v[20:35], v[192:195], v[124:127], v[20:35]
    ds_read_b128 v[132:135], v7 offset:24576
    ds_read_b64_tr_b16 v[208:209], v14 offset:26624
    ds_read_b64_tr_b16 v[210:211], v14 offset:26880
    v_mfma_f32_32x32x16_bf16 v[36:51], v[124:127], v[196:199], v[36:51]
    ds_read_b64_tr_b16 v[212:213], v14 offset:27648
    ds_read_b64_tr_b16 v[214:215], v14 offset:27904
    s_add_u32 s10, s10, 2097152
    s_add_u32 s11, s10, 0x10000
    s_waitcnt lgkmcnt(5)
    v_mfma_f32_32x32x16_bf16 v[20:35], v[200:203], v[128:131], v[20:35]
    ds_read_b128 v[136:139], v8 offset:24576
    ds_read_b64_tr_b16 v[192:193], v14 offset:28672
    ds_read_b64_tr_b16 v[194:195], v14 offset:28928
    v_mfma_f32_32x32x16_bf16 v[36:51], v[128:131], v[204:207], v[36:51]
    ds_read_b64_tr_b16 v[196:197], v14 offset:29696
    ds_read_b64_tr_b16 v[198:199], v14 offset:29952
    s_mov_b32 s13, 0x3eb8aa3b
    s_lshl_b32 s81, s64, 1
    s_waitcnt lgkmcnt(5)
    v_mfma_f32_32x32x16_bf16 v[20:35], v[208:211], v[132:135], v[20:35]
    ds_read_b128 v[140:143], v9 offset:24576
    ds_read_b64_tr_b16 v[200:201], v14 offset:30720
    ds_read_b64_tr_b16 v[202:203], v14 offset:30976
    v_mfma_f32_32x32x16_bf16 v[36:51], v[132:135], v[212:215], v[36:51]
    ds_read_b64_tr_b16 v[204:205], v14 offset:31744
    ds_read_b64_tr_b16 v[206:207], v14 offset:32000
    s_add_u32 s80, s80, s81
    s_lshl_b32 s80, s80, 15
    s_waitcnt lgkmcnt(0)
    s_barrier
    v_mfma_f32_32x32x16_bf16 v[20:35], v[192:195], v[136:139], v[20:35]
    ds_read_b128 v[144:147], v10 offset:0
    ds_read_b64_tr_b16 v[208:209], v15 offset:0
    ds_read_b64_tr_b16 v[210:211], v15 offset:256
    v_mfma_f32_32x32x16_bf16 v[36:51], v[136:139], v[196:199], v[36:51]
    ds_read_b64_tr_b16 v[212:213], v15 offset:1024
    ds_read_b64_tr_b16 v[214:215], v15 offset:1280
    s_lshl_b32 s82, s61, 10
    s_add_u32 s80, s80, s82
    s_add_u32 s86, s80, 11010048
    s_waitcnt lgkmcnt(5)
    v_mfma_f32_32x32x16_bf16 v[20:35], v[200:203], v[140:143], v[20:35]
    ds_read_b128 v[148:151], v11 offset:0
    ds_read_b64_tr_b16 v[192:193], v15 offset:2048
    ds_read_b64_tr_b16 v[194:195], v15 offset:2304
    v_mfma_f32_32x32x16_bf16 v[36:51], v[140:143], v[204:207], v[36:51]
    ds_read_b64_tr_b16 v[196:197], v15 offset:3072
    ds_read_b64_tr_b16 v[198:199], v15 offset:3328
    s_add_u32 s87, s86, 0x8000
    s_mov_b32 s8, 99
    s_waitcnt lgkmcnt(5)
    v_mfma_f32_32x32x16_bf16 v[20:35], v[208:211], v[144:147], v[20:35]
    ds_read_b128 v[152:155], v12 offset:0
    ds_read_b64_tr_b16 v[200:201], v15 offset:4096
    ds_read_b64_tr_b16 v[202:203], v15 offset:4352
    v_mfma_f32_32x32x16_bf16 v[36:51], v[144:147], v[212:215], v[36:51]
    ds_read_b64_tr_b16 v[204:205], v15 offset:5120
    ds_read_b64_tr_b16 v[206:207], v15 offset:5376
    s_lshl_b32 s82, s63, 2
    s_add_u32 s82, s82, s81
    s_waitcnt lgkmcnt(5)
    v_mfma_f32_32x32x16_bf16 v[20:35], v[192:195], v[148:151], v[20:35]
    ds_read_b128 v[156:159], v13 offset:0
    ds_read_b64_tr_b16 v[208:209], v15 offset:6144
    ds_read_b64_tr_b16 v[210:211], v15 offset:6400
    v_mfma_f32_32x32x16_bf16 v[36:51], v[148:151], v[196:199], v[36:51]
    ds_read_b64_tr_b16 v[212:213], v15 offset:7168
    ds_read_b64_tr_b16 v[214:215], v15 offset:7424
    s_mul_i32 s14, s82, 2176
    s_add_u32 s14, s14, 110336
    s_waitcnt lgkmcnt(0)
    s_barrier
    v_mfma_f32_32x32x16_bf16 v[20:35], v[200:203], v[152:155], v[20:35]
    ds_read_b128 v[160:163], v6 offset:0
    ds_read_b64_tr_b16 v[192:193], v14 offset:0
    ds_read_b64_tr_b16 v[194:195], v14 offset:256
    v_mfma_f32_32x32x16_bf16 v[36:51], v[152:155], v[204:207], v[36:51]
    ds_read_b64_tr_b16 v[196:197], v14 offset:1024
    ds_read_b64_tr_b16 v[198:199], v14 offset:1280
    s_xor_b32 s16, s30, 2
    s_mul_i32 s15, s30, 4352
    s_waitcnt lgkmcnt(5)
    v_mfma_f32_32x32x16_bf16 v[20:35], v[208:211], v[156:159], v[20:35]
    ds_read_b128 v[164:167], v7 offset:0
    ds_read_b64_tr_b16 v[200:201], v14 offset:2048
    ds_read_b64_tr_b16 v[202:203], v14 offset:2304
    v_mfma_f32_32x32x16_bf16 v[36:51], v[156:159], v[212:215], v[36:51]
    ds_read_b64_tr_b16 v[204:205], v14 offset:3072
    ds_read_b64_tr_b16 v[206:207], v14 offset:3328
    s_mul_i32 s16, s16, 4352
    s_add_u32 s15, s15, 145152
    s_add_u32 s16, s16, 145152
    s_waitcnt lgkmcnt(5)
    v_mfma_f32_32x32x16_bf16 v[20:35], v[192:195], v[160:163], v[20:35]
    ds_read_b128 v[168:171], v8 offset:0
    ds_read_b64_tr_b16 v[208:209], v14 offset:4096
    ds_read_b64_tr_b16 v[210:211], v14 offset:4352
    v_mfma_f32_32x32x16_bf16 v[36:51], v[160:163], v[196:199], v[36:51]
    ds_read_b64_tr_b16 v[212:213], v14 offset:5120
    ds_read_b64_tr_b16 v[214:215], v14 offset:5376
    s_mov_b32 s83, 2
    s_mov_b32 s82, 99
    s_waitcnt lgkmcnt(5)
    v_mfma_f32_32x32x16_bf16 v[20:35], v[200:203], v[164:167], v[20:35]
    ds_read_b128 v[172:175], v9 offset:0
    ds_read_b64_tr_b16 v[192:193], v14 offset:6144
    ds_read_b64_tr_b16 v[194:195], v14 offset:6400
    v_mfma_f32_32x32x16_bf16 v[36:51], v[164:167], v[204:207], v[36:51]
    ds_read_b64_tr_b16 v[196:197], v14 offset:7168
    ds_read_b64_tr_b16 v[198:199], v14 offset:7424
    s_mov_b32 s92, s18
    s_mov_b32 s93, s19
    s_waitcnt lgkmcnt(0)
    s_barrier
    v_mfma_f32_32x32x16_bf16 v[20:35], v[208:211], v[168:171], v[20:35]
    ds_read_b128 v[176:179], v6 offset:24576
    ds_read_b64_tr_b16 v[200:201], v14 offset:24576
    ds_read_b64_tr_b16 v[202:203], v14 offset:24832
    v_mfma_f32_32x32x16_bf16 v[36:51], v[168:171], v[212:215], v[36:51]
    ds_read_b64_tr_b16 v[204:205], v14 offset:25600
    ds_read_b64_tr_b16 v[206:207], v14 offset:25856
    v_and_b32 v229, 27, v0
    v_cmp_eq_u32 vcc, 16, v229
    s_waitcnt lgkmcnt(5)
    v_mfma_f32_32x32x16_bf16 v[20:35], v[192:195], v[172:175], v[20:35]
    ds_read_b128 v[180:183], v7 offset:24576
    ds_read_b64_tr_b16 v[208:209], v14 offset:26624
    ds_read_b64_tr_b16 v[210:211], v14 offset:26880
    v_mfma_f32_32x32x16_bf16 v[36:51], v[172:175], v[196:199], v[36:51]
    ds_read_b64_tr_b16 v[212:213], v14 offset:27648
    ds_read_b64_tr_b16 v[214:215], v14 offset:27904
    v_mov_b32 v229, 0x3f803f80
    s_nop 0
    v_cndmask_b32 v229, 0, v229, vcc
    s_waitcnt lgkmcnt(5)
    v_mfma_f32_32x32x16_bf16 v[20:35], v[200:203], v[176:179], v[20:35]
    ds_read_b128 v[184:187], v8 offset:24576
    ds_read_b64_tr_b16 v[192:193], v14 offset:28672
    ds_read_b64_tr_b16 v[194:195], v14 offset:28928
    v_mfma_f32_32x32x16_bf16 v[36:51], v[176:179], v[204:207], v[36:51]
    ds_read_b64_tr_b16 v[196:197], v14 offset:29696
    ds_read_b64_tr_b16 v[198:199], v14 offset:29952
    s_waitcnt lgkmcnt(5)
    v_mfma_f32_32x32x16_bf16 v[20:35], v[208:211], v[180:183], v[20:35]
    ds_read_b128 v[188:191], v9 offset:24576
    ds_read_b64_tr_b16 v[200:201], v14 offset:30720
    ds_read_b64_tr_b16 v[202:203], v14 offset:30976
    v_mfma_f32_32x32x16_bf16 v[36:51], v[180:183], v[212:215], v[36:51]
    ds_read_b64_tr_b16 v[204:205], v14 offset:31744
    ds_read_b64_tr_b16 v[206:207], v14 offset:32000
    s_waitcnt lgkmcnt(5)
    v_mfma_f32_32x32x16_bf16 v[20:35], v[192:195], v[184:187], v[20:35]
    v_mfma_f32_32x32x16_bf16 v[36:51], v[184:187], v[196:199], v[36:51]
    s_waitcnt lgkmcnt(0)
    v_mfma_f32_32x32x16_bf16 v[20:35], v[200:203], v[188:191], v[20:35]
    v_mfma_f32_32x32x16_bf16 v[36:51], v[188:191], v[204:207], v[36:51]
    s_setprio 3
    s_nop 9
    v_cvt_pk_bf16_f32 v20, v20, v21
    v_cvt_pk_bf16_f32 v21, v22, v23
    v_cvt_pk_bf16_f32 v22, v24, v25
    v_cvt_pk_bf16_f32 v23, v26, v27
    v_cvt_pk_bf16_f32 v24, v28, v29
    v_cvt_pk_bf16_f32 v25, v30, v31
    v_cvt_pk_bf16_f32 v26, v32, v33
    v_cvt_pk_bf16_f32 v27, v34, v35
    buffer_store_dwordx4 v[20:23], v16, s[32:35], s10 offen sc1
    buffer_store_dwordx4 v[24:27], v16, s[32:35], s11 offen sc1
    v_cvt_pk_bf16_f32 v36, v36, v37
    v_cvt_pk_bf16_f32 v37, v38, v39
    v_cvt_pk_bf16_f32 v38, v40, v41
    v_cvt_pk_bf16_f32 v39, v42, v43
    v_cvt_pk_bf16_f32 v40, v44, v45
    v_cvt_pk_bf16_f32 v41, v46, v47
    v_cvt_pk_bf16_f32 v42, v48, v49
    v_cvt_pk_bf16_f32 v43, v50, v51
    buffer_store_dwordx4 v[36:39], v17, s[32:35], s12 offen sc1
    buffer_store_dwordx4 v[40:43], v17, s[32:35], s12 offen offset:512 sc1
    buffer_load_dword v19, v228, s[52:55], 0 offen sc1
    s_barrier
    v_add_u32 v6, s14, v3
    v_add_u32 v7, s14, v5
    v_add_u32 v8, s15, v3
    v_add_u32 v9, s15, v5
    v_add_u32 v10, s16, v3
    v_add_u32 v11, s16, v5
    v_mov_b32 v192, v229
    v_mov_b32 v193, v229
    v_mov_b32 v194, v229
    v_mov_b32 v195, v229
    v_mov_b32 v196, v229
    v_mov_b32 v197, v229
    v_mov_b32 v198, v229
    v_mov_b32 v199, v229
    v_mov_b32 v200, v229
    v_mov_b32 v201, v229
    v_mov_b32 v202, v229
    v_mov_b32 v203, v229
    v_mov_b32 v204, v229
    v_mov_b32 v205, v229
    v_mov_b32 v206, v229
    v_mov_b32 v207, v229
    s_waitcnt vmcnt(0)
    v_cmp_eq_u32 vcc, 1, v19
    s_nop 0
    s_cmp_eq_u64 vcc, exec
    s_cbranch_scc0 AS8
AS8_ok:
    s_mov_b64 exec, 1
    ds_add_rtn_u32 v12, v252, v253 offset:128
    s_waitcnt lgkmcnt(0)
    v_cmp_eq_u32 vcc, 3, v12
    s_nop 4
    s_cbranch_vccz AR10
    buffer_store_dword v253, v223, s[32:35], s62 offen offset:0 sc1
AR10:
    s_mov_b64 exec, -1
    s_barrier
    ds_read_b64_tr_b16 v[208:209], v1 offset:28672
    ds_read_b64_tr_b16 v[210:211], v1 offset:28928
    ds_read_b64_tr_b16 v[212:213], v1 offset:29696
    ds_read_b64_tr_b16 v[214:215], v1 offset:29952
    ds_read_b64_tr_b16 v[216:217], v1 offset:30720
    ds_read_b64_tr_b16 v[218:219], v1 offset:30976
    ds_read_b64_tr_b16 v[28:29], v1 offset:31744
    ds_read_b64_tr_b16 v[30:31], v1 offset:32000
    s_waitcnt lgkmcnt(6)
    v_mfma_f32_32x32x16_bf16 v[48:63], v[208:211], v[176:179], 0
    ds_read_b64_tr_b16 v[32:33], v1 offset:0
    ds_read_b64_tr_b16 v[34:35], v1 offset:256
    s_waitcnt lgkmcnt(6)
    v_mfma_f32_32x32x16_bf16 v[48:63], v[212:215], v[180:183], v[48:63]
    ds_read_b64_tr_b16 v[208:209], v1 offset:1024
    ds_read_b64_tr_b16 v[210:211], v1 offset:1280
    s_waitcnt lgkmcnt(6)
    v_mfma_f32_32x32x16_bf16 v[48:63], v[216:219], v[184:187], v[48:63]
    ds_read_b64_tr_b16 v[212:213], v1 offset:2048
    ds_read_b64_tr_b16 v[214:215], v1 offset:2304
    s_waitcnt lgkmcnt(6)
    v_mfma_f32_32x32x16_bf16 v[48:63], v[28:31], v[188:191], v[48:63]
    ds_read_b64_tr_b16 v[216:217], v1 offset:3072
    ds_read_b64_tr_b16 v[218:219], v1 offset:3328
    s_waitcnt lgkmcnt(6)
    v_mfma_f32_32x32x16_bf16 v[48:63], v[32:35], v[64:67], v[48:63]
    ds_read_b64_tr_b16 v[28:29], v1 offset:4096
    ds_read_b64_tr_b16 v[30:31], v1 offset:4352
    v_mov_b32 v176, v229
    s_waitcnt lgkmcnt(6)
    v_mfma_f32_32x32x16_bf16 v[48:63], v[208:211], v[68:71], v[48:63]
    ds_read_b64_tr_b16 v[32:33], v1 offset:5120
    ds_read_b64_tr_b16 v[34:35], v1 offset:5376
    v_mov_b32 v177, v229
    s_waitcnt lgkmcnt(6)
    v_mfma_f32_32x32x16_bf16 v[48:63], v[212:215], v[72:75], v[48:63]
    ds_read_b64_tr_b16 v[208:209], v1 offset:6144
    ds_read_b64_tr_b16 v[210:211], v1 offset:6400
    v_mov_b32 v178, v229
    s_waitcnt lgkmcnt(6)
    v_mfma_f32_32x32x16_bf16 v[48:63], v[216:219], v[76:79], v[48:63]
    ds_read_b64_tr_b16 v[212:213], v1 offset:7168
    ds_read_b64_tr_b16 v[214:215], v1 offset:7424
    v_mov_b32 v179, v229
    s_waitcnt lgkmcnt(6)
    v_mfma_f32_32x32x16_bf16 v[48:63], v[28:31], v[80:83], v[48:63]
    ds_read_b64_tr_b16 v[216:217], v1 offset:8192
    ds_read_b64_tr_b16 v[218:219], v1 offset:8448
    v_mov_b32 v180, v229
    s_waitcnt lgkmcnt(6)
    v_mfma_f32_32x32x16_bf16 v[48:63], v[32:35], v[84:87], v[48:63]
    ds_read_b64_tr_b16 v[28:29], v1 offset:9216
    ds_read_b64_tr_b16 v[30:31], v1 offset:9472
    v_mov_b32 v181, v229
    s_waitcnt lgkmcnt(6)
    v_mfma_f32_32x32x16_bf16 v[48:63], v[208:211], v[88:91], v[48:63]
    ds_read_b64_tr_b16 v[32:33], v1 offset:10240
    ds_read_b64_tr_b16 v[34:35], v1 offset:10496
    v_mov_b32 v182, v229
    s_waitcnt lgkmcnt(6)
    v_mfma_f32_32x32x16_bf16 v[48:63], v[212:215], v[92:95], v[48:63]
    ds_read_b64_tr_b16 v[208:209], v1 offset:11264
    ds_read_b64_tr_b16 v[210:211], v1 offset:11520
    v_mov_b32 v183, v229
    s_waitcnt lgkmcnt(6)
    v_mfma_f32_32x32x16_bf16 v[48:63], v[216:219], v[96:99], v[48:63]
    ds_read_b64_tr_b16 v[212:213], v1 offset:12288
    ds_read_b64_tr_b16 v[214:215], v1 offset:12544
    v_mov_b32 v184, v229
    s_waitcnt lgkmcnt(6)
    v_mfma_f32_32x32x16_bf16 v[48:63], v[28:31], v[100:103], v[48:63]
    ds_read_b64_tr_b16 v[216:217], v1 offset:13312
    ds_read_b64_tr_b16 v[218:219], v1 offset:13568
    v_mov_b32 v185, v229
    buffer_load_dword v12, v222, s[32:35], s74 offen sc1
    s_waitcnt lgkmcnt(6)
    v_mfma_f32_32x32x16_bf16 v[48:63], v[32:35], v[104:107], v[48:63]
    ds_read_b64_tr_b16 v[28:29], v1 offset:14336
    ds_read_b64_tr_b16 v[30:31], v1 offset:14592
    v_mov_b32 v186, v229
    s_waitcnt lgkmcnt(6)
    v_mfma_f32_32x32x16_bf16 v[48:63], v[208:211], v[108:111], v[48:63]
    ds_read_b64_tr_b16 v[32:33], v1 offset:15360
    ds_read_b64_tr_b16 v[34:35], v1 offset:15616
    v_mov_b32 v187, v229
    s_waitcnt lgkmcnt(6)
    v_mfma_f32_32x32x16_bf16 v[48:63], v[212:215], v[112:115], v[48:63]
    ds_read_b64_tr_b16 v[208:209], v1 offset:16384
    ds_read_b64_tr_b16 v[210:211], v1 offset:16640
    v_mov_b32 v188, v229
    s_waitcnt lgkmcnt(6)
    v_mfma_f32_32x32x16_bf16 v[48:63], v[216:219], v[116:119], v[48:63]
    ds_read_b64_tr_b16 v[212:213], v1 offset:17408
    ds_read_b64_tr_b16 v[214:215], v1 offset:17664
    v_mov_b32 v189, v229
    s_waitcnt lgkmcnt(6)
    v_mfma_f32_32x32x16_bf16 v[48:63], v[28:31], v[120:123], v[48:63]
    ds_read_b64_tr_b16 v[216:217], v1 offset:18432
    ds_read_b64_tr_b16 v[218:219], v1 offset:18688
    v_mov_b32 v190, v229
    s_waitcnt lgkmcnt(6)
    v_mfma_f32_32x32x16_bf16 v[48:63], v[32:35], v[124:127], v[48:63]
    ds_read_b64_tr_b16 v[28:29], v1 offset:19456
    ds_read_b64_tr_b16 v[30:31], v1 offset:19712
    v_mov_b32 v191, v229
    s_waitcnt lgkmcnt(6)
    v_mfma_f32_32x32x16_bf16 v[48:63], v[208:211], v[128:131], v[48:63]
    ds_read_b64_tr_b16 v[32:33], v1 offset:20480
    ds_read_b64_tr_b16 v[34:35], v1 offset:20736
    s_waitcnt lgkmcnt(6)
    v_mfma_f32_32x32x16_bf16 v[48:63], v[212:215], v[132:135], v[48:63]
    ds_read_b64_tr_b16 v[208:209], v1 offset:21504
    ds_read_b64_tr_b16 v[210:211], v1 offset:21760
    s_waitcnt lgkmcnt(6)
    v_mfma_f32_32x32x16_bf16 v[48:63], v[216:219], v[136:139], v[48:63]
    ds_read_b64_tr_b16 v[212:213], v1 offset:22528
    ds_read_b64_tr_b16 v[214:215], v1 offset:22784
    s_waitcnt lgkmcnt(6)
    v_mfma_f32_32x32x16_bf16 v[48:63], v[28:31], v[140:143], v[48:63]
    ds_read_b64_tr_b16 v[216:217], v1 offset:23552
    ds_read_b64_tr_b16 v[218:219], v1 offset:23808
    s_waitcnt lgkmcnt(6)
    v_mfma_f32_32x32x16_bf16 v[48:63], v[32:35], v[144:147], v[48:63]
    ds_read_b64_tr_b16 v[28:29], v1 offset:24576
    ds_read_b64_tr_b16 v[30:31], v1 offset:24832
    s_waitcnt lgkmcnt(6)
    v_mfma_f32_32x32x16_bf16 v[48:63], v[208:211], v[148:151], v[48:63]
    ds_read_b64_tr_b16 v[32:33], v1 offset:25600
    ds_read_b64_tr_b16 v[34:35], v1 offset:25856
    s_waitcnt lgkmcnt(6)
    v_mfma_f32_32x32x16_bf16 v[48:63], v[212:215], v[152:155], v[48:63]
    ds_read_b64_tr_b16 v[208:209], v1 offset:26624
    ds_read_b64_tr_b16 v[210:211], v1 offset:26880
    s_waitcnt lgkmcnt(6)
    v_mfma_f32_32x32x16_bf16 v[48:63], v[216:219], v[156:159], v[48:63]
    ds_read_b64_tr_b16 v[212:213], v1 offset:27648
    ds_read_b64_tr_b16 v[214:215], v1 offset:27904
    s_waitcnt lgkmcnt(6)
    v_mfma_f32_32x32x16_bf16 v[48:63], v[28:31], v[160:163], v[48:63]
    s_waitcnt lgkmcnt(4)
    v_mfma_f32_32x32x16_bf16 v[48:63], v[32:35], v[164:167], v[48:63]
    s_waitcnt lgkmcnt(2)
    v_mfma_f32_32x32x16_bf16 v[48:63], v[208:211], v[168:171], v[48:63]
    s_waitcnt lgkmcnt(0)
    v_mfma_f32_32x32x16_bf16 v[48:63], v[212:215], v[172:175], v[48:63]
    s_nop 11
    v_mul_f32 v48, s13, v48
    v_mul_f32 v49, s13, v49
    v_mul_f32 v50, s13, v50
    v_mul_f32 v51, s13, v51
    v_mul_f32 v52, s13, v52
    v_mul_f32 v53, s13, v53
    v_mul_f32 v54, s13, v54
    v_mul_f32 v55, s13, v55
    v_mul_f32 v56, s13, v56
    v_mul_f32 v57, s13, v57
    v_mul_f32 v58, s13, v58
    v_mul_f32 v59, s13, v59
    v_mul_f32 v60, s13, v60
    v_mul_f32 v61, s13, v61
    v_mul_f32 v62, s13, v62
    v_mul_f32 v63, s13, v63
    v_cvt_pk_bf16_f32 v48, v48, v49
    v_cvt_pk_bf16_f32 v49, v50, v51
    v_cvt_pk_bf16_f32 v50, v52, v53
    v_cvt_pk_bf16_f32 v51, v54, v55
    v_cvt_pk_bf16_f32 v52, v56, v57
    v_cvt_pk_bf16_f32 v53, v58, v59
    v_cvt_pk_bf16_f32 v54, v60, v61
    v_cvt_pk_bf16_f32 v55, v62, v63
    ds_write_b128 v18, v[48:51]
    ds_write_b128 v18, v[52:55] offset:4096
    s_waitcnt lgkmcnt(0)
    ds_write_b32 v242, v253 offset:16
    s_waitcnt vmcnt(0)
    v_cmp_eq_u32 vcc, 1, v12
    s_nop 0
    s_cmp_eq_u64 vcc, exec
    s_cbranch_scc0 AS11
AS11_ok:
    buffer_load_dwordx4 v[160:163], v3, s[32:35], s70 offen offset:0 sc1
    s_mov_b64 exec, s[72:73]
    buffer_load_dwordx4 v[176:179], v4, s[32:35], s71 offen offset:0 sc1
    buffer_load_dwordx4 v[180:183], v4, s[32:35], s71 offen offset:512 sc1
    s_mov_b64 exec, -1
    buffer_load_dwordx4 v[164:167], v3, s[32:35], s70 offen offset:1024 sc1
    s_mov_b64 exec, s[72:73]
    buffer_load_dwordx4 v[184:187], v4, s[32:35], s71 offen offset:1024 sc1
    buffer_load_dwordx4 v[188:191], v4, s[32:35], s71 offen offset:1536 sc1
    s_mov_b64 exec, -1
    buffer_load_dwordx4 v[168:171], v3, s[32:35], s70 offen offset:2048 sc1
    s_mov_b64 exec, s[72:73]
    buffer_load_dwordx4 v[192:195], v4, s[32:35], s71 offen offset:2048 sc1
    buffer_load_dwordx4 v[196:199], v4, s[32:35], s71 offen offset:2560 sc1
    s_mov_b64 exec, -1
    buffer_load_dwordx4 v[172:175], v3, s[32:35], s70 offen offset:3072 sc1
    s_mov_b32 s90, 0x400000
LW13:
    ds_read_b32 v16, v243 offset:16
    s_waitcnt lgkmcnt(0)
    v_cmp_eq_u32 vcc, 1, v16
    s_sub_u32 s90, s90, 1
    s_cbranch_scc1 LW13_out
    s_cmp_eq_u64 vcc, exec
    s_cbranch_scc0 LW13
LW13_out:
    ds_read_b128 v[16:19], v246 offset:0
    ds_read_b128 v[20:23], v246 offset:1024
    ds_read_b128 v[24:27], v247 offset:0
    ds_read_b128 v[28:31], v247 offset:1024
    s_waitcnt lgkmcnt(0)
    ds_write_b32 v242, v253 offset:80
    s_setprio 2
B_go:
    v_mfma_f32_32x32x16_bf16 v[32:47], v[248:251], v[248:251], 0
    v_mfma_f32_32x32x16_bf16 v[48:63], v[248:251], v[248:251], 0
    v_mfma_f32_32x32x16_bf16 v[64:79], v[248:251], v[248:251], 0
    v_mfma_f32_32x32x16_bf16 v[80:95], v[248:251], v[248:251], 0
    v_mfma_f32_32x32x16_bf16 v[144:159], v[248:251], v[248:251], 0
    s_add_u32 s70, s70, 4096
    s_add_u32 s71, s71, 3072
    s_mov_b32 s84, 3
    s_waitcnt vmcnt(9)
    v_mfma_f32_32x32x16_bf16 v[96:111], v[160:163], v[16:19], 0
    v_mfma_f32_32x32x16_bf16 v[112:127], v[160:163], v[20:23], 0
    v_mov_b32 v248, -1
    v_mov_b32 v249, -1
    v_mov_b32 v250, -1
    v_mov_b32 v251, -1
    s_nop 6
.p2align 6
B_loop:
    v_exp_f32 v96, v96
    v_smfmac_f32_32x32x32_bf16 v[80:95], v[200:203], v[144:151], v2
    v_exp_f32 v97, v97
    v_exp_f32 v98, v98
    s_cmp_lg_u32 s84, s83
    s_cbranch_scc1 B_keep
    s_setprio 0
B_keep:
    v_exp_f32 v99, v99
    v_exp_f32 v100, v100
    v_exp_f32 v101, v101
    v_smfmac_f32_32x32x32_bf16 v[80:95], v[204:207], v[152:159], v2
    v_exp_f32 v102, v102
    v_exp_f32 v103, v103
    s_mov_b64 exec, s[72:73]
    buffer_load_dwordx4 v[200:203], v4, s[32:35], s71 offen offset:0 sc1
    buffer_load_dwordx4 v[204:207], v4, s[32:35], s71 offen offset:512 sc1
    s_mov_b64 exec, -1
    v_exp_f32 v104, v104
    v_exp_f32 v105, v105
    v_exp_f32 v106, v106
    v_mfma_f32_32x32x16_bf16 v[128:143], v[160:163], v[24:27], 0
    v_exp_f32 v107, v107
    v_exp_f32 v108, v108
    v_exp_f32 v109, v109
    v_exp_f32 v110, v110
    v_exp_f32 v111, v111
    v_exp_f32 v112, v112
    s_waitcnt vmcnt(8)
    v_smfmac_f32_32x32x32_bf16 v[32:47], v[176:179], v[96:103], v2
    v_exp_f32 v113, v113
    v_exp_f32 v114, v114
    v_exp_f32 v115, v115
    v_exp_f32 v116, v116
    v_exp_f32 v117, v117
    v_smfmac_f32_32x32x32_bf16 v[32:47], v[180:183], v[104:111], v2
    v_exp_f32 v118, v118
    v_exp_f32 v119, v119
    v_exp_f32 v120, v120
    v_exp_f32 v121, v121
    v_exp_f32 v122, v122
    v_mfma_f32_32x32x16_bf16 v[144:159], v[160:163], v[28:31], 0
    v_exp_f32 v123, v123
    v_exp_f32 v124, v124
    buffer_load_dwordx4 v[160:163], v3, s[32:35], s70 offen offset:0 sc1
    v_exp_f32 v125, v125
    v_exp_f32 v126, v126
    v_exp_f32 v127, v127
    v_exp_f32 v128, v128
    v_smfmac_f32_32x32x32_bf16 v[48:63], v[176:179], v[112:119], v2
    v_exp_f32 v129, v129
    v_exp_f32 v130, v130
    v_exp_f32 v131, v131
    v_exp_f32 v132, v132
    v_exp_f32 v133, v133
    v_smfmac_f32_32x32x32_bf16 v[48:63], v[180:183], v[120:127], v2
    v_exp_f32 v134, v134
    v_exp_f32 v135, v135
    s_add_u32 m0, s77, 0
    s_add_u32 s85, s78, 0
    buffer_load_dwordx4 v244, s[44:47], s85 offen lds
    v_exp_f32 v136, v136
    v_exp_f32 v137, v137
    v_exp_f32 v138, v138
    v_mfma_f32_32x32x16_bf16 v[96:111], v[164:167], v[16:19], 0
    v_exp_f32 v139, v139
    v_exp_f32 v140, v140
    v_exp_f32 v141, v141
    v_exp_f32 v142, v142
    v_exp_f32 v143, v143
    v_exp_f32 v144, v144
    v_smfmac_f32_32x32x32_bf16 v[64:79], v[176:179], v[128:135], v2
    v_exp_f32 v145, v145
    v_exp_f32 v146, v146
    v_exp_f32 v147, v147
    v_exp_f32 v148, v148
    v_exp_f32 v149, v149
    v_smfmac_f32_32x32x32_bf16 v[64:79], v[180:183], v[136:143], v2
    v_exp_f32 v150, v150
    v_exp_f32 v151, v151
    v_exp_f32 v152, v152
    v_exp_f32 v153, v153
    v_exp_f32 v154, v154
    v_mfma_f32_32x32x16_bf16 v[112:127], v[164:167], v[20:23], 0
    v_exp_f32 v155, v155
    v_exp_f32 v156, v156
    v_exp_f32 v157, v157
    v_exp_f32 v158, v158
    v_exp_f32 v159, v159
    v_exp_f32 v96, v96
    v_smfmac_f32_32x32x32_bf16 v[80:95], v[176:179], v[144:151], v2
    v_exp_f32 v97, v97
    v_exp_f32 v98, v98
    v_exp_f32 v99, v99
    v_exp_f32 v100, v100
    v_exp_f32 v101, v101
    v_smfmac_f32_32x32x32_bf16 v[80:95], v[180:183], v[152:159], v2
    v_exp_f32 v102, v102
    v_exp_f32 v103, v103
    s_mov_b64 exec, s[72:73]
    buffer_load_dwordx4 v[176:179], v4, s[32:35], s71 offen offset:1024 sc1
    buffer_load_dwordx4 v[180:183], v4, s[32:35], s71 offen offset:1536 sc1
    s_mov_b64 exec, -1
    v_exp_f32 v104, v104
    v_exp_f32 v105, v105
    v_exp_f32 v106, v106
    v_mfma_f32_32x32x16_bf16 v[128:143], v[164:167], v[24:27], 0
    v_exp_f32 v107, v107
    v_exp_f32 v108, v108
    v_exp_f32 v109, v109
    v_exp_f32 v110, v110
    v_exp_f32 v111, v111
    v_exp_f32 v112, v112
    s_waitcnt vmcnt(9)
    v_smfmac_f32_32x32x32_bf16 v[32:47], v[184:187], v[96:103], v2
    v_exp_f32 v113, v113
    v_exp_f32 v114, v114
    v_exp_f32 v115, v115
    v_exp_f32 v116, v116
    v_exp_f32 v117, v117
    v_smfmac_f32_32x32x32_bf16 v[32:47], v[188:191], v[104:111], v2
    v_exp_f32 v118, v118
    v_exp_f32 v119, v119
    v_exp_f32 v120, v120
    v_exp_f32 v121, v121
    v_exp_f32 v122, v122
    v_mfma_f32_32x32x16_bf16 v[144:159], v[164:167], v[28:31], 0
    v_exp_f32 v123, v123
    v_exp_f32 v124, v124
    buffer_load_dwordx4 v[164:167], v3, s[32:35], s70 offen offset:1024 sc1
    v_exp_f32 v125, v125
    v_exp_f32 v126, v126
    v_exp_f32 v127, v127
    v_exp_f32 v128, v128
    v_smfmac_f32_32x32x32_bf16 v[48:63], v[184:187], v[112:119], v2
    v_exp_f32 v129, v129
    v_exp_f32 v130, v130
    v_exp_f32 v131, v131
    v_exp_f32 v132, v132
    v_exp_f32 v133, v133
    v_smfmac_f32_32x32x32_bf16 v[48:63], v[188:191], v[120:127], v2
    v_exp_f32 v134, v134
    v_exp_f32 v135, v135
    s_add_u32 m0, s77, 1024
    s_add_u32 s85, s78, 16384
    buffer_load_dwordx4 v244, s[44:47], s85 offen lds
    v_exp_f32 v136, v136
    v_exp_f32 v137, v137
    v_exp_f32 v138, v138
    v_mfma_f32_32x32x16_bf16 v[96:111], v[168:171], v[16:19], 0
    v_exp_f32 v139, v139
    v_exp_f32 v140, v140
    v_exp_f32 v141, v141
    v_exp_f32 v142, v142
    v_exp_f32 v143, v143
    v_exp_f32 v144, v144
    v_smfmac_f32_32x32x32_bf16 v[64:79], v[184:187], v[128:135], v2
    v_exp_f32 v145, v145
    v_exp_f32 v146, v146
    v_exp_f32 v147, v147
    s_cmp_lg_u32 s84, 3
    s_cbranch_scc1 B_nof
    buffer_load_dword v247, v241, s[32:35], s74 offen sc1
B_nof:
    v_exp_f32 v148, v148
    v_exp_f32 v149, v149
    v_smfmac_f32_32x32x32_bf16 v[64:79], v[188:191], v[136:143], v2
    v_exp_f32 v150, v150
    v_exp_f32 v151, v151
    v_exp_f32 v152, v152
    v_exp_f32 v153, v153
    v_exp_f32 v154, v154
    v_mfma_f32_32x32x16_bf16 v[112:127], v[168:171], v[20:23], 0
    v_exp_f32 v155, v155
    v_exp_f32 v156, v156
    v_exp_f32 v157, v157
    v_exp_f32 v158, v158
    v_exp_f32 v159, v159
    v_exp_f32 v96, v96
    v_smfmac_f32_32x32x32_bf16 v[80:95], v[184:187], v[144:151], v2
    v_exp_f32 v97, v97
    v_exp_f32 v98, v98
    v_exp_f32 v99, v99
    v_exp_f32 v100, v100
    v_exp_f32 v101, v101
    v_smfmac_f32_32x32x32_bf16 v[80:95], v[188:191], v[152:159], v2
    v_exp_f32 v102, v102
    v_exp_f32 v103, v103
    s_mov_b64 exec, s[72:73]
    buffer_load_dwordx4 v[184:187], v4, s[32:35], s71 offen offset:2048 sc1
    buffer_load_dwordx4 v[188:191], v4, s[32:35], s71 offen offset:2560 sc1
    s_mov_b64 exec, -1
    v_exp_f32 v104, v104
    v_exp_f32 v105, v105
    v_exp_f32 v106, v106
    v_mfma_f32_32x32x16_bf16 v[128:143], v[168:171], v[24:27], 0
    v_exp_f32 v107, v107
    v_exp_f32 v108, v108
    v_exp_f32 v109, v109
    v_exp_f32 v110, v110
    v_exp_f32 v111, v111
    v_exp_f32 v112, v112
    s_waitcnt vmcnt(10)
    v_smfmac_f32_32x32x32_bf16 v[32:47], v[192:195], v[96:103], v2
    v_exp_f32 v113, v113
    v_exp_f32 v114, v114
    v_exp_f32 v115, v115
    v_exp_f32 v116, v116
    v_exp_f32 v117, v117
    v_smfmac_f32_32x32x32_bf16 v[32:47], v[196:199], v[104:111], v2
    v_exp_f32 v118, v118
    v_exp_f32 v119, v119
    v_exp_f32 v120, v120
    v_exp_f32 v121, v121
    v_exp_f32 v122, v122
    v_mfma_f32_32x32x16_bf16 v[144:159], v[168:171], v[28:31], 0
    v_exp_f32 v123, v123
    v_exp_f32 v124, v124
    buffer_load_dwordx4 v[168:171], v3, s[32:35], s70 offen offset:2048 sc1
    v_exp_f32 v125, v125
    v_exp_f32 v126, v126
    v_exp_f32 v127, v127
    v_exp_f32 v128, v128
    v_smfmac_f32_32x32x32_bf16 v[48:63], v[192:195], v[112:119], v2
    v_exp_f32 v129, v129
    v_exp_f32 v130, v130
    v_exp_f32 v131, v131
    v_exp_f32 v132, v132
    v_exp_f32 v133, v133
    v_smfmac_f32_32x32x32_bf16 v[48:63], v[196:199], v[120:127], v2
    v_exp_f32 v134, v134
    v_exp_f32 v135, v135
    s_cmp_eq_u32 s84, 1
    s_cbranch_scc1 B_x
    s_add_u32 m0, s77, 2048
    s_add_u32 s85, s78, 32768
    buffer_load_dwordx4 v244, s[44:47], s85 offen lds
    s_branch B_xd
B_x:
    s_mov_b32 m0, s79
    s_nop 0
    buffer_load_dwordx4 v245, s[36:39], 0 offen lds
B_xd:
    v_exp_f32 v136, v136
    v_exp_f32 v137, v137
    v_exp_f32 v138, v138
    v_mfma_f32_32x32x16_bf16 v[96:111], v[172:175], v[16:19], 0
    v_exp_f32 v139, v139
    v_exp_f32 v140, v140
    v_exp_f32 v141, v141
    v_exp_f32 v142, v142
    v_exp_f32 v143, v143
    v_exp_f32 v144, v144
    v_smfmac_f32_32x32x32_bf16 v[64:79], v[192:195], v[128:135], v2
    v_exp_f32 v145, v145
    v_exp_f32 v146, v146
    v_exp_f32 v147, v147
    v_exp_f32 v148, v148
    v_exp_f32 v149, v149
    v_smfmac_f32_32x32x32_bf16 v[64:79], v[196:199], v[136:143], v2
    v_exp_f32 v150, v150
    v_exp_f32 v151, v151
    v_exp_f32 v152, v152
    v_exp_f32 v153, v153
    v_exp_f32 v154, v154
    v_mfma_f32_32x32x16_bf16 v[112:127], v[172:175], v[20:23], 0
    v_exp_f32 v155, v155
    v_exp_f32 v156, v156
    v_exp_f32 v157, v157
    v_exp_f32 v158, v158
    v_exp_f32 v159, v159
    v_exp_f32 v96, v96
    v_smfmac_f32_32x32x32_bf16 v[80:95], v[192:195], v[144:151], v2
    v_exp_f32 v97, v97
    v_exp_f32 v98, v98
    v_exp_f32 v99, v99
    v_exp_f32 v100, v100
    v_exp_f32 v101, v101
    v_smfmac_f32_32x32x32_bf16 v[80:95], v[196:199], v[152:159], v2
    v_exp_f32 v102, v102
    v_exp_f32 v103, v103
    s_mov_b64 exec, s[72:73]
    buffer_load_dwordx4 v[192:195], v4, s[32:35], s71 offen offset:3072 sc1
    buffer_load_dwordx4 v[196:199], v4, s[32:35], s71 offen offset:3584 sc1
    s_mov_b64 exec, -1
    v_exp_f32 v104, v104
    v_exp_f32 v105, v105
    v_exp_f32 v106, v106
    v_mfma_f32_32x32x16_bf16 v[128:143], v[172:175], v[24:27], 0
    v_exp_f32 v107, v107
    v_exp_f32 v108, v108
    v_exp_f32 v109, v109
    v_exp_f32 v110, v110
    v_exp_f32 v111, v111
    v_exp_f32 v112, v112
    s_waitcnt vmcnt(11)
    v_smfmac_f32_32x32x32_bf16 v[32:47], v[200:203], v[96:103], v2
    v_exp_f32 v113, v113
    v_exp_f32 v114, v114
    v_exp_f32 v115, v115
    v_exp_f32 v116, v116
    v_exp_f32 v117, v117
    v_smfmac_f32_32x32x32_bf16 v[32:47], v[204:207], v[104:111], v2
    v_exp_f32 v118, v118
    v_exp_f32 v119, v119
    v_exp_f32 v120, v120
    v_exp_f32 v121, v121
    v_exp_f32 v122, v122
    v_mfma_f32_32x32x16_bf16 v[144:159], v[172:175], v[28:31], 0
    v_exp_f32 v123, v123
    v_exp_f32 v124, v124
    buffer_load_dwordx4 v[172:175], v3, s[32:35], s70 offen offset:3072 sc1
    v_exp_f32 v125, v125
    s_add_u32 s77, s77, 3072
    s_add_u32 s78, s78, 49152
    v_exp_f32 v126, v126
    v_exp_f32 v127, v127
    v_exp_f32 v128, v128
    v_smfmac_f32_32x32x32_bf16 v[48:63], v[200:203], v[112:119], v2
    v_exp_f32 v129, v129
    v_exp_f32 v130, v130
    v_exp_f32 v131, v131
    v_exp_f32 v132, v132
    v_exp_f32 v133, v133
    v_smfmac_f32_32x32x32_bf16 v[48:63], v[204:207], v[120:127], v2
    v_exp_f32 v134, v134
    v_exp_f32 v135, v135
    s_cmp_le_u32 s84, s8
    s_cbranch_scc1 B_nocl
    buffer_store_dwordx4 v[248:251], v3, s[32:35], s88 offen sc1
    buffer_store_dwordx4 v[248:251], v3, s[32:35], s89 offen sc1
    s_mov_b32 s88, s4
    s_mov_b32 s89, s5
B_nocl:
    v_exp_f32 v136, v136
    v_exp_f32 v137, v137
    v_exp_f32 v138, v138
    v_mfma_f32_32x32x16_bf16 v[96:111], v[160:163], v[16:19], 0
    v_exp_f32 v139, v139
    v_exp_f32 v140, v140
    v_exp_f32 v141, v141
    s_add_u32 s70, s70, 4096
    s_add_u32 s71, s71, 4096
    s_sub_u32 s84, s84, 1
    v_exp_f32 v142, v142
    v_exp_f32 v143, v143
    v_exp_f32 v144, v144
    v_smfmac_f32_32x32x32_bf16 v[64:79], v[200:203], v[128:135], v2
    v_exp_f32 v145, v145
    v_exp_f32 v146, v146
    s_cmp_lg_u32 s84, 2
    s_cbranch_scc1 B_nof2
    s_waitcnt vmcnt(7)
    v_cmp_eq_u32 vcc, 1, v247
    s_nop 0
    s_cmp_eq_u64 vcc, exec
    s_cbranch_scc0 AS14
AS14_ok:
B_nof2:
    v_exp_f32 v147, v147
    v_exp_f32 v148, v148
    v_exp_f32 v149, v149
    v_smfmac_f32_32x32x32_bf16 v[64:79], v[204:207], v[136:143], v2
    v_exp_f32 v150, v150
    v_exp_f32 v151, v151
    s_cmp_lg_u32 s84, s82
    s_cbranch_scc1 B_nouf
    s_mov_b64 exec, 1
    ds_add_rtn_u32 v246, v252, v253 offset:132
    s_waitcnt lgkmcnt(0)
    v_cmp_eq_u32 vcc, 3, v246
    s_nop 4
    s_cbranch_vccz AR16
    buffer_store_dword v253, v223, s[32:35], s62 offen offset:4 sc1
AR16:
    s_mov_b64 exec, -1
    s_load_dword s100, s[92:93], 1536
    s_load_dword s100, s[92:93], 1664
    s_load_dword s100, s[92:93], 1792
    s_load_dword s100, s[92:93], 1920
B_nouf:
    v_exp_f32 v152, v152
    v_exp_f32 v153, v153
    v_exp_f32 v154, v154
    v_mfma_f32_32x32x16_bf16 v[112:127], v[160:163], v[20:23], 0
    v_exp_f32 v155, v155
    v_exp_f32 v156, v156
    v_exp_f32 v157, v157
    s_cmp_lg_u32 s84, 0
    v_exp_f32 v158, v158
    v_exp_f32 v159, v159
    s_cbranch_scc1 B_loop
    s_cmp_lt_u32 s30, 4
    s_cbranch_scc1 B_final
    s_lshl_b32 s80, s91, 12
    s_add_u32 s92, s18, s80
    s_addc_u32 s93, s19, 0
    s_mov_b32 s94, 4096
    s_mov_b32 s95, 0x20000
    buffer_load_dword v212, v210, s[32:35], s87 offen sc1
    buffer_load_dword v213, v211, s[32:35], s86 offen sc1
    v_exp_f32 v96, v96
    v_smfmac_f32_32x32x32_bf16 v[80:95], v[200:203], v[144:151], v2
    v_exp_f32 v97, v97
    v_exp_f32 v98, v98
    s_mov_b64 exec, 1
    ds_add_rtn_u32 v246, v252, v253 offset:136
    s_waitcnt lgkmcnt(0)
    v_cmp_eq_u32 vcc, 3, v246
    s_nop 4
    s_cbranch_vccz AR17
    buffer_store_dword v253, v223, s[32:35], s62 offen offset:8 sc1
AR17:
    s_mov_b64 exec, -1
    v_exp_f32 v99, v99
    v_exp_f32 v100, v100
    v_exp_f32 v101, v101
    v_smfmac_f32_32x32x32_bf16 v[80:95], v[204:207], v[152:159], v2
    v_exp_f32 v102, v102
    v_exp_f32 v103, v103
    s_mov_b64 exec, s[72:73]
    buffer_load_dwordx4 v[200:203], v4, s[32:35], s71 offen offset:0 sc1
    buffer_load_dwordx4 v[204:207], v4, s[32:35], s71 offen offset:512 sc1
    s_mov_b64 exec, -1
    v_exp_f32 v104, v104
    v_exp_f32 v105, v105
    v_exp_f32 v106, v106
    v_mfma_f32_32x32x16_bf16 v[128:143], v[160:163], v[24:27], 0
    v_exp_f32 v107, v107
    v_exp_f32 v108, v108
    v_exp_f32 v109, v109
    v_exp_f32 v110, v110
    v_exp_f32 v111, v111
    v_exp_f32 v112, v112
    s_waitcnt vmcnt(12)
    v_smfmac_f32_32x32x32_bf16 v[32:47], v[176:179], v[96:103], v2
    v_exp_f32 v113, v113
    v_exp_f32 v114, v114
    v_exp_f32 v115, v115
    v_exp_f32 v116, v116
    v_exp_f32 v117, v117
    v_smfmac_f32_32x32x32_bf16 v[32:47], v[180:183], v[104:111], v2
    v_exp_f32 v118, v118
    v_exp_f32 v119, v119
    v_exp_f32 v120, v120
    v_exp_f32 v121, v121
    v_exp_f32 v122, v122
    v_mfma_f32_32x32x16_bf16 v[144:159], v[160:163], v[28:31], 0
    v_exp_f32 v123, v123
    v_exp_f32 v124, v124
    v_exp_f32 v125, v125
    v_exp_f32 v126, v126
    v_exp_f32 v127, v127
    v_exp_f32 v128, v128
    v_smfmac_f32_32x32x32_bf16 v[48:63], v[176:179], v[112:119], v2
    v_exp_f32 v129, v129
    v_exp_f32 v130, v130
    v_exp_f32 v131, v131
    v_exp_f32 v132, v132
    v_exp_f32 v133, v133
    v_smfmac_f32_32x32x32_bf16 v[48:63], v[180:183], v[120:127], v2
    v_exp_f32 v134, v134
    v_exp_f32 v135, v135
    v_exp_f32 v136, v136
    v_exp_f32 v137, v137
    v_exp_f32 v138, v138
    v_mfma_f32_32x32x16_bf16 v[96:111], v[164:167], v[16:19], 0
    v_exp_f32 v139, v139
    v_exp_f32 v140, v140
    v_exp_f32 v141, v141
    v_exp_f32 v142, v142
    v_exp_f32 v143, v143
    v_exp_f32 v144, v144
    v_smfmac_f32_32x32x32_bf16 v[64:79], v[176:179], v[128:135], v2
    v_exp_f32 v145, v145
    v_exp_f32 v146, v146
    v_exp_f32 v147, v147
    v_exp_f32 v148, v148
    v_exp_f32 v149, v149
    v_smfmac_f32_32x32x32_bf16 v[64:79], v[180:183], v[136:143], v2
    v_exp_f32 v150, v150
    v_exp_f32 v151, v151
    v_exp_f32 v152, v152
    v_exp_f32 v153, v153
    v_exp_f32 v154, v154
    v_mfma_f32_32x32x16_bf16 v[112:127], v[164:167], v[20:23], 0
    v_exp_f32 v155, v155
    v_exp_f32 v156, v156
    v_exp_f32 v157, v157
    v_exp_f32 v158, v158
    v_exp_f32 v159, v159
    v_exp_f32 v96, v96
    v_smfmac_f32_32x32x32_bf16 v[80:95], v[176:179], v[144:151], v2
    v_exp_f32 v97, v97
    v_exp_f32 v98, v98
    v_exp_f32 v99, v99
    v_exp_f32 v100, v100
    v_exp_f32 v101, v101
    v_smfmac_f32_32x32x32_bf16 v[80:95], v[180:183], v[152:159], v2
    v_exp_f32 v102, v102
    v_exp_f32 v103, v103
    v_exp_f32 v104, v104
    v_exp_f32 v105, v105
    v_exp_f32 v106, v106
    v_mfma_f32_32x32x16_bf16 v[128:143], v[164:167], v[24:27], 0
    v_exp_f32 v107, v107
    v_exp_f32 v108, v108
    v_exp_f32 v109, v109
    v_exp_f32 v110, v110
    v_exp_f32 v111, v111
    v_exp_f32 v112, v112
    s_waitcnt vmcnt(2)
    v_smfmac_f32_32x32x32_bf16 v[32:47], v[184:187], v[96:103], v2
    v_exp_f32 v113, v113
    v_exp_f32 v114, v114
    ds_write_b32 v242, v253 offset:160
    v_cmp_eq_u32 vcc, 1, v212
    s_nop 0
    s_cmp_eq_u64 vcc, exec
    s_cbranch_scc0 AS18
AS18_ok:
    v_cmp_eq_u32 vcc, 1, v213
    s_nop 0
    s_cmp_eq_u64 vcc, exec
    s_cbranch_scc0 AS20
AS20_ok:
    v_exp_f32 v115, v115
    v_exp_f32 v116, v116
    v_exp_f32 v117, v117
    v_smfmac_f32_32x32x32_bf16 v[32:47], v[188:191], v[104:111], v2
    v_exp_f32 v118, v118
    v_exp_f32 v119, v119
    s_add_u32 m0, s65, 4576
    s_nop 0
    buffer_load_dwordx4 v3, s[32:35], s13 offen offset:0 sc1 lds
    buffer_load_dwordx4 v3, s[32:35], s13 offen offset:1024 sc1 lds
    v_exp_f32 v120, v120
    v_exp_f32 v121, v121
    v_exp_f32 v122, v122
    v_mfma_f32_32x32x16_bf16 v[144:159], v[164:167], v[28:31], 0
    v_exp_f32 v123, v123
    v_exp_f32 v124, v124
    s_add_u32 m0, s65, 4576
    s_nop 0
    buffer_load_dwordx4 v3, s[32:35], s13 offen offset:2048 sc1 lds
    buffer_load_dwordx4 v3, s[32:35], s13 offen offset:3072 sc1 lds
    v_exp_f32 v125, v125
    v_exp_f32 v126, v126
    v_exp_f32 v127, v127
    v_exp_f32 v128, v128
    v_smfmac_f32_32x32x32_bf16 v[48:63], v[184:187], v[112:119], v2
    v_exp_f32 v129, v129
    v_exp_f32 v130, v130
    v_exp_f32 v131, v131
    s_add_u32 m0, s65, 0
    s_nop 0
    buffer_load_dwordx4 v11, s[32:35], s13 offen offset:0 sc1 lds
    buffer_load_dwordx4 v11, s[32:35], s13 offen offset:1024 sc1 lds
    v_exp_f32 v132, v132
    v_exp_f32 v133, v133
    v_smfmac_f32_32x32x32_bf16 v[48:63], v[188:191], v[120:127], v2
    v_exp_f32 v134, v134
    v_exp_f32 v135, v135
    v_exp_f32 v136, v136
    v_exp_f32 v137, v137
    v_exp_f32 v138, v138
    v_mfma_f32_32x32x16_bf16 v[96:111], v[168:171], v[16:19], 0
    v_exp_f32 v139, v139
    v_exp_f32 v140, v140
    s_add_u32 m0, s65, 0
    s_nop 0
    buffer_load_dwordx4 v11, s[32:35], s13 offen offset:2048 sc1 lds
    buffer_load_dwordx4 v11, s[32:35], s13 offen offset:3072 sc1 lds
    v_exp_f32 v141, v141
    v_exp_f32 v142, v142
    v_exp_f32 v143, v143
    v_exp_f32 v144, v144
    v_smfmac_f32_32x32x32_bf16 v[64:79], v[184:187], v[128:135], v2
    v_exp_f32 v145, v145
    v_exp_f32 v146, v146
    v_exp_f32 v147, v147
    buffer_load_dword v208, v5, s[32:35], s14 offen sc1
    v_exp_f32 v148, v148
    v_exp_f32 v149, v149
    v_smfmac_f32_32x32x32_bf16 v[64:79], v[188:191], v[136:143], v2
    v_exp_f32 v150, v150
    v_exp_f32 v151, v151
    v_exp_f32 v152, v152
    v_exp_f32 v153, v153
    v_exp_f32 v154, v154
    v_mfma_f32_32x32x16_bf16 v[112:127], v[168:171], v[20:23], 0
    v_exp_f32 v155, v155
    v_exp_f32 v156, v156
    v_exp_f32 v157, v157
    v_exp_f32 v158, v158
    v_exp_f32 v159, v159
    v_exp_f32 v96, v96
    v_smfmac_f32_32x32x32_bf16 v[80:95], v[184:187], v[144:151], v2
    v_exp_f32 v97, v97
    v_exp_f32 v98, v98
    v_exp_f32 v99, v99
    v_exp_f32 v100, v100
    v_exp_f32 v101, v101
    v_smfmac_f32_32x32x32_bf16 v[80:95], v[188:191], v[152:159], v2
    v_exp_f32 v102, v102
    v_exp_f32 v103, v103
    v_exp_f32 v104, v104
    v_exp_f32 v105, v105
    v_exp_f32 v106, v106
    v_mfma_f32_32x32x16_bf16 v[128:143], v[168:171], v[24:27], 0
    v_exp_f32 v107, v107
    v_exp_f32 v108, v108
    v_exp_f32 v109, v109
    v_exp_f32 v110, v110
    v_exp_f32 v111, v111
    v_exp_f32 v112, v112
    v_smfmac_f32_32x32x32_bf16 v[32:47], v[192:195], v[96:103], v2
    v_exp_f32 v113, v113
    v_exp_f32 v114, v114
    v_exp_f32 v115, v115
    v_exp_f32 v116, v116
    v_exp_f32 v117, v117
    v_smfmac_f32_32x32x32_bf16 v[32:47], v[196:199], v[104:111], v2
    v_exp_f32 v118, v118
    v_exp_f32 v119, v119
    v_exp_f32 v120, v120
    v_exp_f32 v121, v121
    v_exp_f32 v122, v122
    v_mfma_f32_32x32x16_bf16 v[144:159], v[168:171], v[28:31], 0
    v_exp_f32 v123, v123
    v_exp_f32 v124, v124
    v_exp_f32 v125, v125
    v_exp_f32 v126, v126
    v_exp_f32 v127, v127
    v_exp_f32 v128, v128
    v_smfmac_f32_32x32x32_bf16 v[48:63], v[192:195], v[112:119], v2
    v_exp_f32 v129, v129
    v_exp_f32 v130, v130
    v_exp_f32 v131, v131
    v_exp_f32 v132, v132
    v_exp_f32 v133, v133
    v_smfmac_f32_32x32x32_bf16 v[48:63], v[196:199], v[120:127], v2
    v_exp_f32 v134, v134
    v_exp_f32 v135, v135
    v_exp_f32 v136, v136
    v_exp_f32 v137, v137
    v_exp_f32 v138, v138
    v_mfma_f32_32x32x16_bf16 v[96:111], v[172:175], v[16:19], 0
    v_exp_f32 v139, v139
    v_exp_f32 v140, v140
    v_exp_f32 v141, v141
    v_exp_f32 v142, v142
    v_exp_f32 v143, v143
    v_exp_f32 v144, v144
    v_smfmac_f32_32x32x32_bf16 v[64:79], v[192:195], v[128:135], v2
    v_exp_f32 v145, v145
    v_exp_f32 v146, v146
    v_exp_f32 v147, v147
    v_exp_f32 v148, v148
    v_exp_f32 v149, v149
    v_smfmac_f32_32x32x32_bf16 v[64:79], v[196:199], v[136:143], v2
    v_exp_f32 v150, v150
    v_exp_f32 v151, v151
    v_exp_f32 v152, v152
    v_exp_f32 v153, v153
    v_exp_f32 v154, v154
    v_mfma_f32_32x32x16_bf16 v[112:127], v[172:175], v[20:23], 0
    v_exp_f32 v155, v155
    v_exp_f32 v156, v156
    v_exp_f32 v157, v157
    v_exp_f32 v158, v158
    v_exp_f32 v159, v159
    v_exp_f32 v96, v96
    v_smfmac_f32_32x32x32_bf16 v[80:95], v[192:195], v[144:151], v2
    v_exp_f32 v97, v97
    v_exp_f32 v98, v98
    v_exp_f32 v99, v99
    v_exp_f32 v100, v100
    v_exp_f32 v101, v101
    v_smfmac_f32_32x32x32_bf16 v[80:95], v[196:199], v[152:159], v2
    v_exp_f32 v102, v102
    v_exp_f32 v103, v103
    v_exp_f32 v104, v104
    v_exp_f32 v105, v105
    v_exp_f32 v106, v106
    v_mfma_f32_32x32x16_bf16 v[128:143], v[172:175], v[24:27], 0
    v_exp_f32 v107, v107
    v_exp_f32 v108, v108
    v_exp_f32 v109, v109
    v_exp_f32 v110, v110
    v_exp_f32 v111, v111
    v_exp_f32 v112, v112
    s_waitcnt vmcnt(9)
    v_smfmac_f32_32x32x32_bf16 v[32:47], v[200:203], v[96:103], v2
    v_exp_f32 v113, v113
    v_exp_f32 v114, v114
    v_exp_f32 v115, v115
    v_exp_f32 v116, v116
    v_exp_f32 v117, v117
    v_smfmac_f32_32x32x32_bf16 v[32:47], v[204:207], v[104:111], v2
    v_exp_f32 v118, v118
    v_exp_f32 v119, v119
    v_exp_f32 v120, v120
    buffer_load_dwordx4 v[160:163], v9, s[92:95], 0 offen offset:0
    v_exp_f32 v121, v121
    buffer_load_dwordx4 v[164:167], v10, s[92:95], 0 offen offset:64
    v_exp_f32 v122, v122
    v_mfma_f32_32x32x16_bf16 v[144:159], v[172:175], v[28:31], 0
    buffer_load_dwordx4 v[168:171], v10, s[92:95], 0 offen offset:576
    v_exp_f32 v123, v123
    buffer_load_dwordx4 v[172:175], v10, s[92:95], 0 offen offset:1088
    v_exp_f32 v124, v124
    v_exp_f32 v125, v125
    v_exp_f32 v126, v126
    v_exp_f32 v127, v127
    v_exp_f32 v128, v128
    v_smfmac_f32_32x32x32_bf16 v[48:63], v[200:203], v[112:119], v2
    v_exp_f32 v129, v129
    v_exp_f32 v130, v130
    ds_write_b128 v6, v[32:35] offset:0
    v_exp_f32 v131, v131
    ds_write_b128 v6, v[36:39] offset:1024
    v_exp_f32 v132, v132
    ds_write_b32 v7, v40 offset:2048
    v_exp_f32 v133, v133
    v_smfmac_f32_32x32x32_bf16 v[48:63], v[204:207], v[120:127], v2
    v_exp_f32 v134, v134
    v_exp_f32 v135, v135
    buffer_load_dwordx4 v[176:179], v10, s[92:95], 0 offen offset:1600
    v_exp_f32 v136, v136
    buffer_load_dwordx4 v[180:183], v10, s[92:95], 0 offen offset:2112
    v_exp_f32 v137, v137
    buffer_load_dwordx4 v[184:187], v10, s[92:95], 0 offen offset:2624
    v_exp_f32 v138, v138
    buffer_load_dwordx4 v[188:191], v10, s[92:95], 0 offen offset:3136
    v_exp_f32 v139, v139
    v_exp_f32 v140, v140
    v_exp_f32 v141, v141
    v_exp_f32 v142, v142
    v_exp_f32 v143, v143
    buffer_load_dword v96, v8, s[92:95], 0 offen
    v_add_u32 v8, 4, v8
    buffer_load_dword v97, v8, s[92:95], 0 offen
    v_add_u32 v8, 4, v8
    buffer_load_dword v98, v8, s[92:95], 0 offen
    v_add_u32 v8, 4, v8
    buffer_load_dword v99, v8, s[92:95], 0 offen
    v_exp_f32 v144, v144
    v_smfmac_f32_32x32x32_bf16 v[64:79], v[200:203], v[128:135], v2
    v_exp_f32 v145, v145
    v_exp_f32 v146, v146
    ds_write_b128 v6, v[48:51] offset:2176
    v_exp_f32 v147, v147
    ds_write_b128 v6, v[52:55] offset:3200
    v_exp_f32 v148, v148
    ds_write_b32 v7, v56 offset:4224
    v_exp_f32 v149, v149
    v_smfmac_f32_32x32x32_bf16 v[64:79], v[204:207], v[136:143], v2
    v_exp_f32 v150, v150
    buffer_load_dwordx4 v[100:103], v10, s[92:95], 0 offen offset:0
    v_exp_f32 v151, v151
    buffer_load_dwordx4 v[104:107], v10, s[92:95], 0 offen offset:512
    v_exp_f32 v152, v152
    buffer_load_dwordx4 v[108:111], v10, s[92:95], 0 offen offset:1024
    v_exp_f32 v153, v153
    buffer_load_dwordx4 v[112:115], v10, s[92:95], 0 offen offset:1536
    v_exp_f32 v154, v154
    buffer_load_dwordx4 v[116:119], v10, s[92:95], 0 offen offset:2048
    v_exp_f32 v155, v155
    buffer_load_dwordx4 v[120:123], v10, s[92:95], 0 offen offset:2560
    v_exp_f32 v156, v156
    buffer_load_dwordx4 v[124:127], v10, s[92:95], 0 offen offset:3072
    v_exp_f32 v157, v157
    v_exp_f32 v158, v158
    v_exp_f32 v159, v159
    s_waitcnt vmcnt(19)
    s_mov_b64 exec, 1
    ds_write_b16 v12, v223 offset:4094
    s_mov_b64 exec, -1
    v_smfmac_f32_32x32x32_bf16 v[80:95], v[200:203], v[144:151], v2
    v_smfmac_f32_32x32x32_bf16 v[80:95], v[204:207], v[152:159], v2
    s_setprio 0
    ds_read_b128 v[128:131], v1 offset:3584
    ds_read_b128 v[132:135], v1 offset:3072
    ds_read_b128 v[136:139], v1 offset:2560
    ds_read_b128 v[140:143], v1 offset:2048
    ds_read_b128 v[144:147], v1 offset:1536
    ds_read_b128 v[148:151], v1 offset:1024
    ds_read_b128 v[152:155], v1 offset:512
    ds_read_b128 v[156:159], v1 offset:0
    ds_write_b128 v6, v[64:67] offset:4352
    ds_write_b128 v6, v[68:71] offset:5376
    ds_write_b32 v7, v72 offset:6400
    s_nop 0
    ds_write_b128 v6, v[80:83] offset:6528
    ds_write_b128 v6, v[84:87] offset:7552
    ds_write_b32 v7, v88 offset:8576
    s_waitcnt lgkmcnt(0)
    ds_write_b32 v242, v253 offset:64
    s_waitcnt vmcnt(0)
    s_cmp_lg_u32 s63, 0
    s_cbranch_scc1 CV_nodiag
    v_mfma_f32_16x16x32_bf16 v[32:35], v[218:221], v[128:131], 0
    v_mfma_f32_16x16x32_bf16 v[36:39], v[218:221], v[132:135], 0
    v_mfma_f32_16x16x32_bf16 v[40:43], v[218:221], v[136:139], 0
    v_mfma_f32_16x16x32_bf16 v[44:47], v[218:221], v[140:143], 0
    v_mfma_f32_16x16x32_bf16 v[48:51], v[218:221], v[144:147], 0
    v_mfma_f32_16x16x32_bf16 v[52:55], v[218:221], v[148:151], 0
    v_mfma_f32_16x16x32_bf16 v[56:59], v[218:221], v[152:155], 0
    v_mfma_f32_16x16x32_bf16 v[60:63], v[218:221], v[156:159], 0
    v_mfma_f32_16x16x32_bf16 v[32:35], v[96:99], v[128:131], v[32:35]
    v_mfma_f32_16x16x32_bf16 v[36:39], v[96:99], v[132:135], v[36:39]
    v_mfma_f32_16x16x32_bf16 v[40:43], v[96:99], v[136:139], v[40:43]
    v_mfma_f32_16x16x32_bf16 v[44:47], v[96:99], v[140:143], v[44:47]
    v_mfma_f32_16x16x32_bf16 v[48:51], v[96:99], v[144:147], v[48:51]
    v_mfma_f32_16x16x32_bf16 v[52:55], v[96:99], v[148:151], v[52:55]
    v_mfma_f32_16x16x32_bf16 v[56:59], v[96:99], v[152:155], v[56:59]
    v_mfma_f32_16x16x32_bf16 v[60:63], v[96:99], v[156:159], v[60:63]
    s_branch CV_row1
CV_nodiag:
    v_mfma_f32_16x16x32_bf16 v[32:35], v[96:99], v[128:131], 0
    v_mfma_f32_16x16x32_bf16 v[36:39], v[96:99], v[132:135], 0
    v_mfma_f32_16x16x32_bf16 v[40:43], v[96:99], v[136:139], 0
    v_mfma_f32_16x16x32_bf16 v[44:47], v[96:99], v[140:143], 0
    v_mfma_f32_16x16x32_bf16 v[48:51], v[96:99], v[144:147], 0
    v_mfma_f32_16x16x32_bf16 v[52:55], v[96:99], v[148:151], 0
    v_mfma_f32_16x16x32_bf16 v[56:59], v[96:99], v[152:155], 0
    v_mfma_f32_16x16x32_bf16 v[60:63], v[96:99], v[156:159], 0
CV_row1:
    buffer_load_dwordx4 v[96:99], v9, s[92:95], 0 offen offset:64
    v_mfma_f32_16x16x32_bf16 v[36:39], v[100:103], v[128:131], v[36:39]
    v_mfma_f32_16x16x32_bf16 v[40:43], v[100:103], v[132:135], v[40:43]
    v_mfma_f32_16x16x32_bf16 v[44:47], v[100:103], v[136:139], v[44:47]
    ds_read_b128 v[64:67], v1 offset:3648
    v_mfma_f32_16x16x32_bf16 v[48:51], v[100:103], v[140:143], v[48:51]
    v_mfma_f32_16x16x32_bf16 v[52:55], v[100:103], v[144:147], v[52:55]
    v_mfma_f32_16x16x32_bf16 v[56:59], v[100:103], v[148:151], v[56:59]
    ds_read_b128 v[68:71], v1 offset:3136
    v_mfma_f32_16x16x32_bf16 v[60:63], v[100:103], v[152:155], v[60:63]
    buffer_load_dwordx4 v[100:103], v10, s[92:95], 0 offen offset:128
    v_mfma_f32_16x16x32_bf16 v[40:43], v[104:107], v[128:131], v[40:43]
    v_mfma_f32_16x16x32_bf16 v[44:47], v[104:107], v[132:135], v[44:47]
    ds_read_b128 v[72:75], v1 offset:2624
    v_mfma_f32_16x16x32_bf16 v[48:51], v[104:107], v[136:139], v[48:51]
    v_mfma_f32_16x16x32_bf16 v[52:55], v[104:107], v[140:143], v[52:55]
    v_mfma_f32_16x16x32_bf16 v[56:59], v[104:107], v[144:147], v[56:59]
    ds_read_b128 v[76:79], v1 offset:2112
    v_mfma_f32_16x16x32_bf16 v[60:63], v[104:107], v[148:151], v[60:63]
    buffer_load_dwordx4 v[104:107], v10, s[92:95], 0 offen offset:640
    v_mfma_f32_16x16x32_bf16 v[44:47], v[108:111], v[128:131], v[44:47]
    v_mfma_f32_16x16x32_bf16 v[48:51], v[108:111], v[132:135], v[48:51]
    ds_read_b128 v[80:83], v1 offset:1600
    v_mfma_f32_16x16x32_bf16 v[52:55], v[108:111], v[136:139], v[52:55]
    v_mfma_f32_16x16x32_bf16 v[56:59], v[108:111], v[140:143], v[56:59]
    v_mfma_f32_16x16x32_bf16 v[60:63], v[108:111], v[144:147], v[60:63]
    ds_read_b128 v[84:87], v1 offset:1088
    buffer_load_dwordx4 v[108:111], v10, s[92:95], 0 offen offset:1152
    v_mfma_f32_16x16x32_bf16 v[48:51], v[112:115], v[128:131], v[48:51]
    v_mfma_f32_16x16x32_bf16 v[52:55], v[112:115], v[132:135], v[52:55]
    v_mfma_f32_16x16x32_bf16 v[56:59], v[112:115], v[136:139], v[56:59]
    ds_read_b128 v[88:91], v1 offset:576
    v_mfma_f32_16x16x32_bf16 v[60:63], v[112:115], v[140:143], v[60:63]
    buffer_load_dwordx4 v[112:115], v10, s[92:95], 0 offen offset:1664
    v_mfma_f32_16x16x32_bf16 v[52:55], v[116:119], v[128:131], v[52:55]
    v_mfma_f32_16x16x32_bf16 v[56:59], v[116:119], v[132:135], v[56:59]
    ds_read_b128 v[92:95], v1 offset:64
    v_mfma_f32_16x16x32_bf16 v[60:63], v[116:119], v[136:139], v[60:63]
    buffer_load_dwordx4 v[116:119], v10, s[92:95], 0 offen offset:2176
    v_mfma_f32_16x16x32_bf16 v[56:59], v[120:123], v[128:131], v[56:59]
    v_mfma_f32_16x16x32_bf16 v[60:63], v[120:123], v[132:135], v[60:63]
    buffer_load_dwordx4 v[120:123], v10, s[92:95], 0 offen offset:2688
    v_mfma_f32_16x16x32_bf16 v[60:63], v[124:127], v[128:131], v[60:63]
    buffer_load_dwordx4 v[124:127], v10, s[92:95], 0 offen offset:3200
    s_waitcnt vmcnt(8) lgkmcnt(0)
    v_mfma_f32_16x16x32_bf16 v[32:35], v[160:163], v[64:67], v[32:35]
    v_mfma_f32_16x16x32_bf16 v[36:39], v[160:163], v[68:71], v[36:39]
    v_mfma_f32_16x16x32_bf16 v[40:43], v[160:163], v[72:75], v[40:43]
    ds_read_b128 v[128:131], v1 offset:3712
    v_mfma_f32_16x16x32_bf16 v[44:47], v[160:163], v[76:79], v[44:47]
    v_mfma_f32_16x16x32_bf16 v[48:51], v[160:163], v[80:83], v[48:51]
    v_mfma_f32_16x16x32_bf16 v[52:55], v[160:163], v[84:87], v[52:55]
    ds_read_b128 v[132:135], v1 offset:3200
    v_mfma_f32_16x16x32_bf16 v[56:59], v[160:163], v[88:91], v[56:59]
    v_mfma_f32_16x16x32_bf16 v[60:63], v[160:163], v[92:95], v[60:63]
    buffer_load_dwordx4 v[160:163], v9, s[92:95], 0 offen offset:128
    v_mfma_f32_16x16x32_bf16 v[36:39], v[164:167], v[64:67], v[36:39]
    ds_read_b128 v[136:139], v1 offset:2688
    v_mfma_f32_16x16x32_bf16 v[40:43], v[164:167], v[68:71], v[40:43]
    v_mfma_f32_16x16x32_bf16 v[44:47], v[164:167], v[72:75], v[44:47]
    v_mfma_f32_16x16x32_bf16 v[48:51], v[164:167], v[76:79], v[48:51]
    ds_read_b128 v[140:143], v1 offset:2176
    v_mfma_f32_16x16x32_bf16 v[52:55], v[164:167], v[80:83], v[52:55]
    v_mfma_f32_16x16x32_bf16 v[56:59], v[164:167], v[84:87], v[56:59]
    v_mfma_f32_16x16x32_bf16 v[60:63], v[164:167], v[88:91], v[60:63]
    ds_read_b128 v[144:147], v1 offset:1664
    buffer_load_dwordx4 v[164:167], v10, s[92:95], 0 offen offset:192
    v_mfma_f32_16x16x32_bf16 v[40:43], v[168:171], v[64:67], v[40:43]
    v_mfma_f32_16x16x32_bf16 v[44:47], v[168:171], v[68:71], v[44:47]
    v_mfma_f32_16x16x32_bf16 v[48:51], v[168:171], v[72:75], v[48:51]
    ds_read_b128 v[148:151], v1 offset:1152
    v_mfma_f32_16x16x32_bf16 v[52:55], v[168:171], v[76:79], v[52:55]
    v_mfma_f32_16x16x32_bf16 v[56:59], v[168:171], v[80:83], v[56:59]
    v_mfma_f32_16x16x32_bf16 v[60:63], v[168:171], v[84:87], v[60:63]
    ds_read_b128 v[152:155], v1 offset:640
    buffer_load_dwordx4 v[168:171], v10, s[92:95], 0 offen offset:704
    v_mfma_f32_16x16x32_bf16 v[44:47], v[172:175], v[64:67], v[44:47]
    v_mfma_f32_16x16x32_bf16 v[48:51], v[172:175], v[68:71], v[48:51]
    v_mfma_f32_16x16x32_bf16 v[52:55], v[172:175], v[72:75], v[52:55]
    ds_read_b128 v[156:159], v1 offset:128
    v_mfma_f32_16x16x32_bf16 v[56:59], v[172:175], v[76:79], v[56:59]
    v_mfma_f32_16x16x32_bf16 v[60:63], v[172:175], v[80:83], v[60:63]
    buffer_load_dwordx4 v[172:175], v10, s[92:95], 0 offen offset:1216
    v_mfma_f32_16x16x32_bf16 v[48:51], v[176:179], v[64:67], v[48:51]
    v_mfma_f32_16x16x32_bf16 v[52:55], v[176:179], v[68:71], v[52:55]
    v_mfma_f32_16x16x32_bf16 v[56:59], v[176:179], v[72:75], v[56:59]
    v_mfma_f32_16x16x32_bf16 v[60:63], v[176:179], v[76:79], v[60:63]
    buffer_load_dwordx4 v[176:179], v10, s[92:95], 0 offen offset:1728
    v_mfma_f32_16x16x32_bf16 v[52:55], v[180:183], v[64:67], v[52:55]
    v_mfma_f32_16x16x32_bf16 v[56:59], v[180:183], v[68:71], v[56:59]
    v_mfma_f32_16x16x32_bf16 v[60:63], v[180:183], v[72:75], v[60:63]
    buffer_load_dwordx4 v[180:183], v10, s[92:95], 0 offen offset:2240
    v_mfma_f32_16x16x32_bf16 v[56:59], v[184:187], v[64:67], v[56:59]
    v_mfma_f32_16x16x32_bf16 v[60:63], v[184:187], v[68:71], v[60:63]
    buffer_load_dwordx4 v[184:187], v10, s[92:95], 0 offen offset:2752
    v_mfma_f32_16x16x32_bf16 v[60:63], v[188:191], v[64:67], v[60:63]
    buffer_load_dwordx4 v[188:191], v10, s[92:95], 0 offen offset:3264
    s_waitcnt vmcnt(8) lgkmcnt(0)
    v_mfma_f32_16x16x32_bf16 v[32:35], v[96:99], v[128:131], v[32:35]
    v_mfma_f32_16x16x32_bf16 v[36:39], v[96:99], v[132:135], v[36:39]
    v_mfma_f32_16x16x32_bf16 v[40:43], v[96:99], v[136:139], v[40:43]
    ds_read_b128 v[64:67], v1 offset:3776
    v_mfma_f32_16x16x32_bf16 v[44:47], v[96:99], v[140:143], v[44:47]
    v_mfma_f32_16x16x32_bf16 v[48:51], v[96:99], v[144:147], v[48:51]
    v_mfma_f32_16x16x32_bf16 v[52:55], v[96:99], v[148:151], v[52:55]
    ds_read_b128 v[68:71], v1 offset:3264
    v_mfma_f32_16x16x32_bf16 v[56:59], v[96:99], v[152:155], v[56:59]
    v_mfma_f32_16x16x32_bf16 v[60:63], v[96:99], v[156:159], v[60:63]
    v_mfma_f32_16x16x32_bf16 v[36:39], v[100:103], v[128:131], v[36:39]
    ds_read_b128 v[72:75], v1 offset:2752
    v_mfma_f32_16x16x32_bf16 v[40:43], v[100:103], v[132:135], v[40:43]
    v_mfma_f32_16x16x32_bf16 v[44:47], v[100:103], v[136:139], v[44:47]
    v_mfma_f32_16x16x32_bf16 v[48:51], v[100:103], v[140:143], v[48:51]
    ds_read_b128 v[76:79], v1 offset:2240
    v_mfma_f32_16x16x32_bf16 v[52:55], v[100:103], v[144:147], v[52:55]
    v_mfma_f32_16x16x32_bf16 v[56:59], v[100:103], v[148:151], v[56:59]
    v_mfma_f32_16x16x32_bf16 v[60:63], v[100:103], v[152:155], v[60:63]
    ds_read_b128 v[80:83], v1 offset:1728
    v_mfma_f32_16x16x32_bf16 v[40:43], v[104:107], v[128:131], v[40:43]
    v_mfma_f32_16x16x32_bf16 v[44:47], v[104:107], v[132:135], v[44:47]
    v_mfma_f32_16x16x32_bf16 v[48:51], v[104:107], v[136:139], v[48:51]
    ds_read_b128 v[84:87], v1 offset:1216
    v_mfma_f32_16x16x32_bf16 v[52:55], v[104:107], v[140:143], v[52:55]
    v_mfma_f32_16x16x32_bf16 v[56:59], v[104:107], v[144:147], v[56:59]
    v_mfma_f32_16x16x32_bf16 v[60:63], v[104:107], v[148:151], v[60:63]
    ds_read_b128 v[88:91], v1 offset:704
    v_mfma_f32_16x16x32_bf16 v[44:47], v[108:111], v[128:131], v[44:47]
    v_mfma_f32_16x16x32_bf16 v[48:51], v[108:111], v[132:135], v[48:51]
    v_mfma_f32_16x16x32_bf16 v[52:55], v[108:111], v[136:139], v[52:55]
    ds_read_b128 v[92:95], v1 offset:192
    v_mfma_f32_16x16x32_bf16 v[56:59], v[108:111], v[140:143], v[56:59]
    v_mfma_f32_16x16x32_bf16 v[60:63], v[108:111], v[144:147], v[60:63]
    v_mfma_f32_16x16x32_bf16 v[48:51], v[112:115], v[128:131], v[48:51]
    v_mfma_f32_16x16x32_bf16 v[52:55], v[112:115], v[132:135], v[52:55]
    v_mfma_f32_16x16x32_bf16 v[56:59], v[112:115], v[136:139], v[56:59]
    v_mfma_f32_16x16x32_bf16 v[60:63], v[112:115], v[140:143], v[60:63]
    v_mfma_f32_16x16x32_bf16 v[52:55], v[116:119], v[128:131], v[52:55]
    v_mfma_f32_16x16x32_bf16 v[56:59], v[116:119], v[132:135], v[56:59]
    v_mfma_f32_16x16x32_bf16 v[60:63], v[116:119], v[136:139], v[60:63]
    v_mfma_f32_16x16x32_bf16 v[56:59], v[120:123], v[128:131], v[56:59]
    v_mfma_f32_16x16x32_bf16 v[60:63], v[120:123], v[132:135], v[60:63]
    v_mfma_f32_16x16x32_bf16 v[60:63], v[124:127], v[128:131], v[60:63]
    s_waitcnt vmcnt(0) lgkmcnt(0)
    s_setprio 1
    buffer_load_dword v212, v210, s[32:35], s17 offen sc1
    buffer_load_dword v213, v240, s[32:35], s101 offen sc1
    v_mfma_f32_16x16x32_bf16 v[32:35], v[160:163], v[64:67], v[32:35]
    v_mfma_f32_16x16x32_bf16 v[36:39], v[160:163], v[68:71], v[36:39]
    v_mfma_f32_16x16x32_bf16 v[40:43], v[160:163], v[72:75], v[40:43]
    v_mfma_f32_16x16x32_bf16 v[44:47], v[160:163], v[76:79], v[44:47]
    v_mfma_f32_16x16x32_bf16 v[48:51], v[160:163], v[80:83], v[48:51]
    v_mfma_f32_16x16x32_bf16 v[52:55], v[160:163], v[84:87], v[52:55]
    v_mfma_f32_16x16x32_bf16 v[56:59], v[160:163], v[88:91], v[56:59]
    v_mfma_f32_16x16x32_bf16 v[60:63], v[160:163], v[92:95], v[60:63]
    v_mfma_f32_16x16x32_bf16 v[36:39], v[164:167], v[64:67], v[36:39]
    v_mfma_f32_16x16x32_bf16 v[40:43], v[164:167], v[68:71], v[40:43]
    v_mfma_f32_16x16x32_bf16 v[44:47], v[164:167], v[72:75], v[44:47]
    v_mfma_f32_16x16x32_bf16 v[48:51], v[164:167], v[76:79], v[48:51]
    v_mfma_f32_16x16x32_bf16 v[52:55], v[164:167], v[80:83], v[52:55]
    v_mfma_f32_16x16x32_bf16 v[56:59], v[164:167], v[84:87], v[56:59]
    v_mfma_f32_16x16x32_bf16 v[60:63], v[164:167], v[88:91], v[60:63]
    v_mfma_f32_16x16x32_bf16 v[40:43], v[168:171], v[64:67], v[40:43]
    v_mfma_f32_16x16x32_bf16 v[44:47], v[168:171], v[68:71], v[44:47]
    v_mfma_f32_16x16x32_bf16 v[48:51], v[168:171], v[72:75], v[48:51]
    v_mfma_f32_16x16x32_bf16 v[52:55], v[168:171], v[76:79], v[52:55]
    v_mfma_f32_16x16x32_bf16 v[56:59], v[168:171], v[80:83], v[56:59]
    v_mfma_f32_16x16x32_bf16 v[60:63], v[168:171], v[84:87], v[60:63]
    v_mfma_f32_16x16x32_bf16 v[44:47], v[172:175], v[64:67], v[44:47]
    v_mfma_f32_16x16x32_bf16 v[48:51], v[172:175], v[68:71], v[48:51]
    v_mfma_f32_16x16x32_bf16 v[52:55], v[172:175], v[72:75], v[52:55]
    v_mfma_f32_16x16x32_bf16 v[56:59], v[172:175], v[76:79], v[56:59]
    v_mfma_f32_16x16x32_bf16 v[60:63], v[172:175], v[80:83], v[60:63]
    v_mfma_f32_16x16x32_bf16 v[48:51], v[176:179], v[64:67], v[48:51]
    v_mfma_f32_16x16x32_bf16 v[52:55], v[176:179], v[68:71], v[52:55]
    v_mfma_f32_16x16x32_bf16 v[56:59], v[176:179], v[72:75], v[56:59]
    v_mfma_f32_16x16x32_bf16 v[60:63], v[176:179], v[76:79], v[60:63]
    v_mfma_f32_16x16x32_bf16 v[52:55], v[180:183], v[64:67], v[52:55]
    v_mfma_f32_16x16x32_bf16 v[56:59], v[180:183], v[68:71], v[56:59]
    v_mfma_f32_16x16x32_bf16 v[60:63], v[180:183], v[72:75], v[60:63]
    v_mfma_f32_16x16x32_bf16 v[56:59], v[184:187], v[64:67], v[56:59]
    v_mfma_f32_16x16x32_bf16 v[60:63], v[184:187], v[68:71], v[60:63]
    v_mfma_f32_16x16x32_bf16 v[60:63], v[188:191], v[64:67], v[60:63]
    s_setprio 3
    s_cmp_lg_u32 s63, 0
    s_cbranch_scc1 CV_odd
    s_nop 4
    ds_write_b128 v12, v[48:51] offset:0
    ds_write_b128 v12, v[52:55] offset:1024
    ds_write_b128 v12, v[56:59] offset:2048
    ds_write_b128 v12, v[60:63] offset:3072
    s_waitcnt lgkmcnt(0)
    ds_write_b32 v242, v253 offset:0
    s_mov_b32 s90, 0x400000
LW22:
    ds_read_b32 v96, v14 offset:0
    s_waitcnt lgkmcnt(0)
    v_cmp_eq_u32 vcc, 1, v96
    s_sub_u32 s90, s90, 1
    s_cbranch_scc1 LW22_out
    s_cmp_eq_u64 vcc, exec
    s_cbranch_scc0 LW22
LW22_out:
    ds_read_b128 v[96:99], v13 offset:0
    ds_read_b128 v[100:103], v13 offset:1024
    ds_read_b128 v[104:107], v13 offset:2048
    ds_read_b128 v[108:111], v13 offset:3072
    s_waitcnt lgkmcnt(3)
    v_pk_add_f32 v[32:33], v[32:33], v[96:97]
    v_pk_add_f32 v[34:35], v[34:35], v[98:99]
    v_cvt_pk_bf16_f32 v128, v32, v33
    v_cvt_pk_bf16_f32 v129, v34, v35
    s_waitcnt lgkmcnt(2)
    v_pk_add_f32 v[36:37], v[36:37], v[100:101]
    v_pk_add_f32 v[38:39], v[38:39], v[102:103]
    v_cvt_pk_bf16_f32 v130, v36, v37
    v_cvt_pk_bf16_f32 v131, v38, v39
    s_waitcnt lgkmcnt(1)
    v_pk_add_f32 v[40:41], v[40:41], v[104:105]
    v_pk_add_f32 v[42:43], v[42:43], v[106:107]
    v_cvt_pk_bf16_f32 v132, v40, v41
    v_cvt_pk_bf16_f32 v133, v42, v43
    s_waitcnt lgkmcnt(0)
    v_pk_add_f32 v[44:45], v[44:45], v[108:109]
    v_pk_add_f32 v[46:47], v[46:47], v[110:111]
    v_cvt_pk_bf16_f32 v134, v44, v45
    v_cvt_pk_bf16_f32 v135, v46, v47
    s_branch CV_st
CV_odd:
    s_nop 0
    ds_write_b128 v12, v[32:35] offset:0
    ds_write_b128 v12, v[36:39] offset:1024
    ds_write_b128 v12, v[40:43] offset:2048
    ds_write_b128 v12, v[44:47] offset:3072
    s_waitcnt lgkmcnt(0)
    ds_write_b32 v242, v253 offset:0
    s_mov_b32 s90, 0x400000
LW23:
    ds_read_b32 v96, v14 offset:0
    s_waitcnt lgkmcnt(0)
    v_cmp_eq_u32 vcc, 1, v96
    s_sub_u32 s90, s90, 1
    s_cbranch_scc1 LW23_out
    s_cmp_eq_u64 vcc, exec
    s_cbranch_scc0 LW23
LW23_out:
    ds_read_b128 v[96:99], v13 offset:0
    ds_read_b128 v[100:103], v13 offset:1024
    ds_read_b128 v[104:107], v13 offset:2048
    ds_read_b128 v[108:111], v13 offset:3072
    s_waitcnt lgkmcnt(3)
    v_pk_add_f32 v[48:49], v[48:49], v[96:97]
    v_pk_add_f32 v[50:51], v[50:51], v[98:99]
    v_cvt_pk_bf16_f32 v128, v48, v49
    v_cvt_pk_bf16_f32 v129, v50, v51
    s_waitcnt lgkmcnt(2)
    v_pk_add_f32 v[52:53], v[52:53], v[100:101]
    v_pk_add_f32 v[54:55], v[54:55], v[102:103]
    v_cvt_pk_bf16_f32 v130, v52, v53
    v_cvt_pk_bf16_f32 v131, v54, v55
    s_waitcnt lgkmcnt(1)
    v_pk_add_f32 v[56:57], v[56:57], v[104:105]
    v_pk_add_f32 v[58:59], v[58:59], v[106:107]
    v_cvt_pk_bf16_f32 v132, v56, v57
    v_cvt_pk_bf16_f32 v133, v58, v59
    s_waitcnt lgkmcnt(0)
    v_pk_add_f32 v[60:61], v[60:61], v[108:109]
    v_pk_add_f32 v[62:63], v[62:63], v[110:111]
    v_cvt_pk_bf16_f32 v134, v60, v61
    v_cvt_pk_bf16_f32 v135, v62, v63
CV_st:
    s_nop 0
    v_permlane16_swap_b32 v128, v130
    v_permlane16_swap_b32 v129, v131
    buffer_store_dwordx4 v[128:131], v15, s[32:35], s7 offen offset:0 sc1
    v_permlane16_swap_b32 v132, v134
    v_permlane16_swap_b32 v133, v135
    buffer_store_dwordx4 v[132:135], v15, s[32:35], s7 offen offset:1024 sc1
    s_waitcnt vmcnt(2)
    v_cmp_eq_u32 vcc, 1, v212
    s_nop 0
    s_cmp_eq_u64 vcc, exec
    s_cbranch_scc0 AS24
AS24_ok:
    v_cmp_eq_u32 vcc, 1, v213
    s_nop 0
    s_cmp_eq_u64 vcc, exec
    s_cbranch_scc0 AS26
AS26_ok:
    s_setprio 3
    s_mov_b32 s90, 0x400000
LW28:
    ds_read_b32 v9, v254 offset:160
    s_waitcnt lgkmcnt(0)
    v_cmp_eq_u32 vcc, 1, v9
    s_sub_u32 s90, s90, 1
    s_cbranch_scc1 LW28_out
    s_cmp_eq_u64 vcc, exec
    s_cbranch_scc0 LW28
LW28_out:
    v_xor_b32 v9, 16, v217
    v_xor_b32 v10, 64, v217
    v_xor_b32 v11, 80, v217
    ds_read_b64 v[192:193], v217
    ds_read_b64 v[194:195], v9
    ds_read_b64 v[196:197], v10
    ds_read_b64 v[198:199], v11
    v_sub_f32 v209, 1.0, v208
    ds_write_b32 v238, v208 offset:2048
    v_xor_b32 v6, 4096, v232
    v_xor_b32 v7, 0x8000, v232
    v_xor_b32 v8, 0x9000, v232
    ds_read_b64_tr_b16 v[16:17], v232 offset:0
    ds_read_b64_tr_b16 v[18:19], v232 offset:512
    ds_read_b64_tr_b16 v[20:21], v232 offset:1024
    ds_read_b64_tr_b16 v[22:23], v232 offset:1536
    ds_read_b64_tr_b16 v[24:25], v232 offset:2048
    ds_read_b64_tr_b16 v[26:27], v232 offset:2560
    ds_read_b64_tr_b16 v[28:29], v232 offset:3072
    ds_read_b64_tr_b16 v[30:31], v232 offset:3584
    s_waitcnt lgkmcnt(4)
    ds_read_b64_tr_b16 v[32:33], v6 offset:0
    ds_read_b64_tr_b16 v[34:35], v6 offset:512
    ds_read_b64_tr_b16 v[36:37], v6 offset:1024
    ds_read_b64_tr_b16 v[38:39], v6 offset:1536
    ds_read_b64_tr_b16 v[40:41], v6 offset:2048
    ds_read_b64_tr_b16 v[42:43], v6 offset:2560
    ds_read_b64_tr_b16 v[44:45], v6 offset:3072
    ds_read_b64_tr_b16 v[46:47], v6 offset:3584
    s_waitcnt lgkmcnt(4)
    ds_read_b64_tr_b16 v[48:49], v7 offset:0
    ds_read_b64_tr_b16 v[50:51], v7 offset:512
    ds_read_b64_tr_b16 v[52:53], v7 offset:1024
    ds_read_b64_tr_b16 v[54:55], v7 offset:1536
    ds_read_b64_tr_b16 v[56:57], v7 offset:2048
    ds_read_b64_tr_b16 v[58:59], v7 offset:2560
    ds_read_b64_tr_b16 v[60:61], v7 offset:3072
    ds_read_b64_tr_b16 v[62:63], v7 offset:3584
    s_waitcnt lgkmcnt(4)
    ds_read_b64_tr_b16 v[64:65], v8 offset:0
    ds_read_b64_tr_b16 v[66:67], v8 offset:512
    ds_read_b64_tr_b16 v[68:69], v8 offset:1024
    ds_read_b64_tr_b16 v[70:71], v8 offset:1536
    ds_read_b64_tr_b16 v[72:73], v8 offset:2048
    ds_read_b64_tr_b16 v[74:75], v8 offset:2560
    ds_read_b64_tr_b16 v[76:77], v8 offset:3072
    ds_read_b64_tr_b16 v[78:79], v8 offset:3584
    v_xor_b32 v9, 16, v216
    v_mov_b32 v210, v209
    v_mov_b32 v211, v209
    v_lshlrev_b32 v112, 16, v192
    v_and_b32 v113, s6, v192
    v_pk_mul_f32 v[112:113], v[112:113], v[210:211]
    v_lshlrev_b32 v114, 16, v193
    v_and_b32 v115, s6, v193
    v_pk_mul_f32 v[114:115], v[114:115], v[210:211]
    v_lshlrev_b32 v116, 16, v194
    v_and_b32 v117, s6, v194
    v_pk_mul_f32 v[116:117], v[116:117], v[210:211]
    v_lshlrev_b32 v118, 16, v195
    v_and_b32 v119, s6, v195
    v_pk_mul_f32 v[118:119], v[118:119], v[210:211]
    v_lshlrev_b32 v120, 16, v196
    v_and_b32 v121, s6, v196
    v_pk_mul_f32 v[120:121], v[120:121], v[210:211]
    v_lshlrev_b32 v122, 16, v197
    v_and_b32 v123, s6, v197
    v_pk_mul_f32 v[122:123], v[122:123], v[210:211]
    v_lshlrev_b32 v124, 16, v198
    v_and_b32 v125, s6, v198
    v_pk_mul_f32 v[124:125], v[124:125], v[210:211]
    v_lshlrev_b32 v126, 16, v199
    v_and_b32 v127, s6, v199
    v_pk_mul_f32 v[126:127], v[126:127], v[210:211]
    buffer_load_dwordx4 v[144:147], v214, s[32:35], s15 offen sc1
    buffer_load_dwordx4 v[148:151], v214, s[32:35], s16 offen sc1
    s_mov_b32 s90, 40000
Y_try:
    ds_read_b32 v11, v243 offset:208
    s_waitcnt vmcnt(0)
    v_max3_u32 v10, v144, v145, v146
    v_max3_u32 v10, v147, v148, v10
    v_max3_u32 v10, v149, v150, v10
    v_max_u32 v10, v151, v10
    v_cmp_eq_u32 vcc, -1, v10
    s_sub_u32 s90, s90, 1
    s_cbranch_scc1 Y_have
    s_cmp_eq_u64 vcc, 0
    s_cbranch_scc1 Y_have
    buffer_load_dwordx4 v[144:147], v214, s[32:35], s15 offen sc1
    buffer_load_dwordx4 v[148:151], v214, s[32:35], s16 offen sc1
    s_waitcnt lgkmcnt(0)
    v_cmp_eq_u32 vcc, 1, v11
    s_nop 0
    s_cmp_eq_u64 vcc, exec
    s_cbranch_scc0 Y_try
    s_setprio 3
    buffer_load_dwordx4 v[80:83], v3, s[32:35], s67 offen offset:0 sc1
    buffer_load_dwordx4 v[84:87], v3, s[32:35], s67 offen offset:1024 sc1
    buffer_load_dwordx4 v[88:91], v3, s[32:35], s67 offen offset:2048 sc1
    buffer_load_dwordx4 v[92:95], v3, s[32:35], s67 offen offset:3072 sc1
    buffer_load_dwordx4 v[96:99], v3, s[32:35], s68 offen offset:0 sc1
    buffer_load_dwordx4 v[100:103], v3, s[32:35], s68 offen offset:1024 sc1
    buffer_load_dwordx4 v[104:107], v3, s[32:35], s68 offen offset:2048 sc1
    buffer_load_dwordx4 v[108:111], v3, s[32:35], s68 offen offset:3072 sc1
    s_waitcnt vmcnt(8)
    v_max3_u32 v10, v144, v145, v146
    v_max3_u32 v10, v147, v148, v10
    v_max3_u32 v10, v149, v150, v10
    v_max_u32 v10, v151, v10
    v_cmp_eq_u32 vcc, -1, v10
    s_nop 0
    s_cmp_eq_u64 vcc, 0
    s_cbranch_scc0 FR29
FR29_ok:
    ds_write_b128 v215, v[144:147]
    ds_write_b128 v215, v[148:151] offset:1024
    s_waitcnt lgkmcnt(0)
    ds_write_b32 v242, v253 offset:192
    s_mov_b32 s90, 0x400000
LW30:
    ds_read_b32 v10, v243 offset:192
    s_waitcnt lgkmcnt(0)
    v_cmp_eq_u32 vcc, 1, v10
    s_sub_u32 s90, s90, 1
    s_cbranch_scc1 LW30_out
    s_cmp_eq_u64 vcc, exec
    s_cbranch_scc0 LW30
LW30_out:
    ds_read_b128 v[184:187], v216 offset:0
    ds_read_b128 v[188:191], v9 offset:0
    ds_read_b128 v[176:179], v216 offset:18304
    ds_read_b128 v[180:183], v9 offset:18304
    s_waitcnt lgkmcnt(2)
    v_mfma_f32_32x32x16_bf16 v[160:175], v[184:187], v[224:227], 0
    v_mfma_f32_32x32x16_bf16 v[160:175], v[188:191], v[228:231], v[160:175]
    s_waitcnt lgkmcnt(0)
    v_mfma_f32_32x32x16_bf16 v[144:159], v[176:179], v[224:227], 0
    v_mfma_f32_32x32x16_bf16 v[144:159], v[180:183], v[228:231], v[144:159]
    s_nop 9
    v_pk_mul_f32 v[160:161], v[160:161], v[120:121]
    v_pk_mul_f32 v[162:163], v[162:163], v[122:123]
    v_pk_mul_f32 v[164:165], v[164:165], v[124:125]
    v_pk_mul_f32 v[166:167], v[166:167], v[126:127]
    ds_write_b128 v237, v[160:163]
    ds_write_b128 v237, v[164:167] offset:1024
    s_nop 0
    v_pk_mul_f32 v[144:145], v[144:145], v[112:113]
    v_pk_mul_f32 v[146:147], v[146:147], v[114:115]
    v_pk_mul_f32 v[148:149], v[148:149], v[116:117]
    v_pk_mul_f32 v[150:151], v[150:151], v[118:119]
    s_branch C_mm
Y_have:
    ds_write_b128 v215, v[144:147]
    ds_write_b128 v215, v[148:151] offset:1024
    s_waitcnt lgkmcnt(0)
    ds_write_b32 v242, v253 offset:192
    s_mov_b32 s90, 0x400000
LW31:
    ds_read_b32 v10, v243 offset:192
    s_waitcnt lgkmcnt(0)
    v_cmp_eq_u32 vcc, 1, v10
    s_sub_u32 s90, s90, 1
    s_cbranch_scc1 LW31_out
    s_cmp_eq_u64 vcc, exec
    s_cbranch_scc0 LW31
LW31_out:
    ds_read_b128 v[184:187], v216 offset:0
    ds_read_b128 v[188:191], v9 offset:0
    ds_read_b128 v[176:179], v216 offset:18304
    ds_read_b128 v[180:183], v9 offset:18304
    s_waitcnt lgkmcnt(2)
    v_mfma_f32_32x32x16_bf16 v[160:175], v[184:187], v[224:227], 0
    v_mfma_f32_32x32x16_bf16 v[160:175], v[188:191], v[228:231], v[160:175]
    s_waitcnt lgkmcnt(0)
    v_mfma_f32_32x32x16_bf16 v[144:159], v[176:179], v[224:227], 0
    v_mfma_f32_32x32x16_bf16 v[144:159], v[180:183], v[228:231], v[144:159]
    s_setprio 0
    s_mov_b32 s90, 0x400000
LW32:
    ds_read_b32 v10, v243 offset:208
    s_waitcnt lgkmcnt(0)
    v_cmp_eq_u32 vcc, 1, v10
    s_sub_u32 s90, s90, 1
    s_cbranch_scc1 LW32_out
    s_cmp_eq_u64 vcc, exec
    s_cbranch_scc0 LW32
LW32_out:
    s_setprio 3
    buffer_load_dwordx4 v[80:83], v3, s[32:35], s67 offen offset:0 sc1
    buffer_load_dwordx4 v[84:87], v3, s[32:35], s67 offen offset:1024 sc1
    buffer_load_dwordx4 v[88:91], v3, s[32:35], s67 offen offset:2048 sc1
    buffer_load_dwordx4 v[92:95], v3, s[32:35], s67 offen offset:3072 sc1
    buffer_load_dwordx4 v[96:99], v3, s[32:35], s68 offen offset:0 sc1
    buffer_load_dwordx4 v[100:103], v3, s[32:35], s68 offen offset:1024 sc1
    buffer_load_dwordx4 v[104:107], v3, s[32:35], s68 offen offset:2048 sc1
    buffer_load_dwordx4 v[108:111], v3, s[32:35], s68 offen offset:3072 sc1
    v_pk_mul_f32 v[160:161], v[160:161], v[120:121]
    v_pk_mul_f32 v[162:163], v[162:163], v[122:123]
    v_pk_mul_f32 v[164:165], v[164:165], v[124:125]
    v_pk_mul_f32 v[166:167], v[166:167], v[126:127]
    ds_write_b128 v237, v[160:163]
    ds_write_b128 v237, v[164:167] offset:1024
    s_nop 0
    v_pk_mul_f32 v[144:145], v[144:145], v[112:113]
    v_pk_mul_f32 v[146:147], v[146:147], v[114:115]
    v_pk_mul_f32 v[148:149], v[148:149], v[116:117]
    v_pk_mul_f32 v[150:151], v[150:151], v[118:119]
    s_branch C_mm
B_final:
    v_exp_f32 v96, v96
    v_smfmac_f32_32x32x32_bf16 v[80:95], v[200:203], v[144:151], v2
    v_exp_f32 v97, v97
    v_exp_f32 v98, v98
    v_exp_f32 v99, v99
    v_exp_f32 v100, v100
    v_exp_f32 v101, v101
    v_smfmac_f32_32x32x32_bf16 v[80:95], v[204:207], v[152:159], v2
    v_exp_f32 v102, v102
    v_exp_f32 v103, v103
    s_mov_b64 exec, s[72:73]
    buffer_load_dwordx4 v[200:203], v4, s[32:35], s71 offen offset:0 sc1
    buffer_load_dwordx4 v[204:207], v4, s[32:35], s71 offen offset:512 sc1
    s_mov_b64 exec, -1
    v_exp_f32 v104, v104
    v_exp_f32 v105, v105
    v_exp_f32 v106, v106
    v_mfma_f32_32x32x16_bf16 v[128:143], v[160:163], v[24:27], 0
    v_exp_f32 v107, v107
    v_exp_f32 v108, v108
    v_exp_f32 v109, v109
    v_exp_f32 v110, v110
    v_exp_f32 v111, v111
    v_exp_f32 v112, v112
    s_waitcnt vmcnt(10)
    v_smfmac_f32_32x32x32_bf16 v[32:47], v[176:179], v[96:103], v2
    v_exp_f32 v113, v113
    v_exp_f32 v114, v114
    v_exp_f32 v115, v115
    v_exp_f32 v116, v116
    v_exp_f32 v117, v117
    v_smfmac_f32_32x32x32_bf16 v[32:47], v[180:183], v[104:111], v2
    v_exp_f32 v118, v118
    v_exp_f32 v119, v119
    v_exp_f32 v120, v120
    v_exp_f32 v121, v121
    v_exp_f32 v122, v122
    v_mfma_f32_32x32x16_bf16 v[144:159], v[160:163], v[28:31], 0
    v_exp_f32 v123, v123
    v_exp_f32 v124, v124
    v_exp_f32 v125, v125
    v_exp_f32 v126, v126
    v_exp_f32 v127, v127
    v_exp_f32 v128, v128
    v_smfmac_f32_32x32x32_bf16 v[48:63], v[176:179], v[112:119], v2
    v_exp_f32 v129, v129
    v_exp_f32 v130, v130
    v_exp_f32 v131, v131
    v_exp_f32 v132, v132
    v_exp_f32 v133, v133
    v_smfmac_f32_32x32x32_bf16 v[48:63], v[180:183], v[120:127], v2
    v_exp_f32 v134, v134
    v_exp_f32 v135, v135
    v_exp_f32 v136, v136
    v_exp_f32 v137, v137
    v_exp_f32 v138, v138
    v_mfma_f32_32x32x16_bf16 v[96:111], v[164:167], v[16:19], 0
    v_exp_f32 v139, v139
    v_exp_f32 v140, v140
    v_exp_f32 v141, v141
    v_exp_f32 v142, v142
    v_exp_f32 v143, v143
    v_exp_f32 v144, v144
    v_smfmac_f32_32x32x32_bf16 v[64:79], v[176:179], v[128:135], v2
    v_exp_f32 v145, v145
    v_exp_f32 v146, v146
    v_exp_f32 v147, v147
    v_exp_f32 v148, v148
    v_exp_f32 v149, v149
    v_smfmac_f32_32x32x32_bf16 v[64:79], v[180:183], v[136:143], v2
    v_exp_f32 v150, v150
    v_exp_f32 v151, v151
    v_exp_f32 v152, v152
    v_exp_f32 v153, v153
    v_exp_f32 v154, v154
    v_mfma_f32_32x32x16_bf16 v[112:127], v[164:167], v[20:23], 0
    v_exp_f32 v155, v155
    v_exp_f32 v156, v156
    v_exp_f32 v157, v157
    v_exp_f32 v158, v158
    v_exp_f32 v159, v159
    v_exp_f32 v96, v96
    v_smfmac_f32_32x32x32_bf16 v[80:95], v[176:179], v[144:151], v2
    v_exp_f32 v97, v97
    v_exp_f32 v98, v98
    v_exp_f32 v99, v99
    v_exp_f32 v100, v100
    v_exp_f32 v101, v101
    v_smfmac_f32_32x32x32_bf16 v[80:95], v[180:183], v[152:159], v2
    v_exp_f32 v102, v102
    v_exp_f32 v103, v103
    v_exp_f32 v104, v104
    v_exp_f32 v105, v105
    v_exp_f32 v106, v106
    v_mfma_f32_32x32x16_bf16 v[128:143], v[164:167], v[24:27], 0
    v_exp_f32 v107, v107
    v_exp_f32 v108, v108
    v_exp_f32 v109, v109
    v_exp_f32 v110, v110
    v_exp_f32 v111, v111
    v_exp_f32 v112, v112
    s_waitcnt vmcnt(5)
    v_smfmac_f32_32x32x32_bf16 v[32:47], v[184:187], v[96:103], v2
    v_exp_f32 v113, v113
    v_exp_f32 v114, v114
    ds_write_b32 v242, v253 offset:176
    v_exp_f32 v115, v115
    v_exp_f32 v116, v116
    v_exp_f32 v117, v117
    v_smfmac_f32_32x32x32_bf16 v[32:47], v[188:191], v[104:111], v2
    v_exp_f32 v118, v118
    v_exp_f32 v119, v119
    v_exp_f32 v120, v120
    v_exp_f32 v121, v121
    v_exp_f32 v122, v122
    v_mfma_f32_32x32x16_bf16 v[144:159], v[164:167], v[28:31], 0
    v_exp_f32 v123, v123
    v_exp_f32 v124, v124
    v_exp_f32 v125, v125
    v_exp_f32 v126, v126
    v_exp_f32 v127, v127
    v_exp_f32 v128, v128
    v_smfmac_f32_32x32x32_bf16 v[48:63], v[184:187], v[112:119], v2
    v_exp_f32 v129, v129
    v_exp_f32 v130, v130
    v_exp_f32 v131, v131
    v_exp_f32 v132, v132
    v_exp_f32 v133, v133
    v_smfmac_f32_32x32x32_bf16 v[48:63], v[188:191], v[120:127], v2
    v_exp_f32 v134, v134
    v_exp_f32 v135, v135
    v_exp_f32 v136, v136
    v_exp_f32 v137, v137
    v_exp_f32 v138, v138
    v_mfma_f32_32x32x16_bf16 v[96:111], v[168:171], v[16:19], 0
    v_exp_f32 v139, v139
    v_exp_f32 v140, v140
    v_exp_f32 v141, v141
    v_exp_f32 v142, v142
    v_exp_f32 v143, v143
    v_exp_f32 v144, v144
    v_smfmac_f32_32x32x32_bf16 v[64:79], v[184:187], v[128:135], v2
    v_exp_f32 v145, v145
    v_exp_f32 v146, v146
    v_exp_f32 v147, v147
    v_exp_f32 v148, v148
    v_exp_f32 v149, v149
    v_smfmac_f32_32x32x32_bf16 v[64:79], v[188:191], v[136:143], v2
    v_exp_f32 v150, v150
    v_exp_f32 v151, v151
    v_exp_f32 v152, v152
    v_exp_f32 v153, v153
    v_exp_f32 v154, v154
    v_mfma_f32_32x32x16_bf16 v[112:127], v[168:171], v[20:23], 0
    v_exp_f32 v155, v155
    v_exp_f32 v156, v156
    v_exp_f32 v157, v157
    v_exp_f32 v158, v158
    v_exp_f32 v159, v159
    v_exp_f32 v96, v96
    v_smfmac_f32_32x32x32_bf16 v[80:95], v[184:187], v[144:151], v2
    v_exp_f32 v97, v97
    v_exp_f32 v98, v98
    v_exp_f32 v99, v99
    v_exp_f32 v100, v100
    v_exp_f32 v101, v101
    v_smfmac_f32_32x32x32_bf16 v[80:95], v[188:191], v[152:159], v2
    v_exp_f32 v102, v102
    v_exp_f32 v103, v103
    v_exp_f32 v104, v104
    v_exp_f32 v105, v105
    v_exp_f32 v106, v106
    v_mfma_f32_32x32x16_bf16 v[128:143], v[168:171], v[24:27], 0
    v_exp_f32 v107, v107
    v_exp_f32 v108, v108
    v_exp_f32 v109, v109
    v_exp_f32 v110, v110
    v_exp_f32 v111, v111
    v_exp_f32 v112, v112
    s_waitcnt vmcnt(2)
    v_smfmac_f32_32x32x32_bf16 v[32:47], v[192:195], v[96:103], v2
    v_exp_f32 v113, v113
    v_exp_f32 v114, v114
    v_exp_f32 v115, v115
    v_exp_f32 v116, v116
    v_exp_f32 v117, v117
    v_smfmac_f32_32x32x32_bf16 v[32:47], v[196:199], v[104:111], v2
    v_exp_f32 v118, v118
    v_exp_f32 v119, v119
    v_exp_f32 v120, v120
    v_exp_f32 v121, v121
    v_exp_f32 v122, v122
    v_mfma_f32_32x32x16_bf16 v[144:159], v[168:171], v[28:31], 0
    v_exp_f32 v123, v123
    v_exp_f32 v124, v124
    v_exp_f32 v125, v125
    v_exp_f32 v126, v126
    v_exp_f32 v127, v127
    v_exp_f32 v128, v128
    v_smfmac_f32_32x32x32_bf16 v[48:63], v[192:195], v[112:119], v2
    v_exp_f32 v129, v129
    v_exp_f32 v130, v130
    v_exp_f32 v131, v131
    v_exp_f32 v132, v132
    v_exp_f32 v133, v133
    v_smfmac_f32_32x32x32_bf16 v[48:63], v[196:199], v[120:127], v2
    v_exp_f32 v134, v134
    v_exp_f32 v135, v135
    buffer_load_dword v13, v240, s[32:35], s101 offen sc1
    v_exp_f32 v136, v136
    v_exp_f32 v137, v137
    v_exp_f32 v138, v138
    v_mfma_f32_32x32x16_bf16 v[96:111], v[172:175], v[16:19], 0
    v_exp_f32 v139, v139
    v_exp_f32 v140, v140
    v_exp_f32 v141, v141
    v_exp_f32 v142, v142
    v_exp_f32 v143, v143
    v_exp_f32 v144, v144
    v_smfmac_f32_32x32x32_bf16 v[64:79], v[192:195], v[128:135], v2
    v_exp_f32 v145, v145
    v_exp_f32 v146, v146
    v_exp_f32 v147, v147
    v_exp_f32 v148, v148
    v_exp_f32 v149, v149
    v_smfmac_f32_32x32x32_bf16 v[64:79], v[196:199], v[136:143], v2
    v_exp_f32 v150, v150
    v_exp_f32 v151, v151
    v_exp_f32 v152, v152
    v_exp_f32 v153, v153
    v_exp_f32 v154, v154
    v_mfma_f32_32x32x16_bf16 v[112:127], v[172:175], v[20:23], 0
    v_exp_f32 v155, v155
    v_exp_f32 v156, v156
    v_exp_f32 v157, v157
    v_exp_f32 v158, v158
    v_exp_f32 v159, v159
    v_exp_f32 v96, v96
    v_smfmac_f32_32x32x32_bf16 v[80:95], v[192:195], v[144:151], v2
    v_exp_f32 v97, v97
    v_exp_f32 v98, v98
    v_exp_f32 v99, v99
    v_exp_f32 v100, v100
    v_exp_f32 v101, v101
    v_smfmac_f32_32x32x32_bf16 v[80:95], v[196:199], v[152:159], v2
    v_exp_f32 v102, v102
    v_exp_f32 v103, v103
    v_exp_f32 v104, v104
    s_mov_b32 s90, 0x400000
LW33:
    ds_read_b32 v12, v243 offset:64
    s_waitcnt lgkmcnt(0)
    v_cmp_eq_u32 vcc, 1, v12
    s_sub_u32 s90, s90, 1
    s_cbranch_scc1 LW33_out
    s_cmp_eq_u64 vcc, exec
    s_cbranch_scc0 LW33
LW33_out:
    s_setprio 3
    v_exp_f32 v105, v105
    v_exp_f32 v106, v106
    v_mfma_f32_32x32x16_bf16 v[128:143], v[172:175], v[24:27], 0
    v_exp_f32 v107, v107
    ds_read_b128 v[208:211], v6 offset:0
    v_exp_f32 v108, v108
    ds_read_b128 v[212:215], v6 offset:1024
    v_exp_f32 v109, v109
    ds_read_b32 v216, v7 offset:2048
    v_exp_f32 v110, v110
    v_exp_f32 v111, v111
    v_exp_f32 v112, v112
    s_waitcnt vmcnt(0)
    v_smfmac_f32_32x32x32_bf16 v[32:47], v[200:203], v[96:103], v2
    v_exp_f32 v113, v113
    v_exp_f32 v114, v114
    ds_read_b128 v[176:179], v6 offset:17408
    v_exp_f32 v115, v115
    ds_read_b128 v[180:183], v6 offset:18432
    v_exp_f32 v116, v116
    v_exp_f32 v117, v117
    v_smfmac_f32_32x32x32_bf16 v[32:47], v[204:207], v[104:111], v2
    v_exp_f32 v118, v118
    v_exp_f32 v119, v119
    ds_read_b32 v184, v7 offset:19456
    v_exp_f32 v120, v120
    ds_read_b128 v[160:163], v6 offset:2176
    v_exp_f32 v121, v121
    v_exp_f32 v122, v122
    v_mfma_f32_32x32x16_bf16 v[144:159], v[172:175], v[28:31], 0
    v_exp_f32 v123, v123
    v_exp_f32 v124, v124
    ds_read_b128 v[164:167], v6 offset:3200
    v_exp_f32 v125, v125
    ds_read_b32 v168, v7 offset:4224
    v_exp_f32 v126, v126
    v_exp_f32 v127, v127
    v_exp_f32 v128, v128
    v_smfmac_f32_32x32x32_bf16 v[48:63], v[200:203], v[112:119], v2
    v_exp_f32 v129, v129
    ds_read_b128 v[186:189], v6 offset:19584
    v_exp_f32 v130, v130
    ds_write_b128 v8, v[32:35] offset:0
    v_exp_f32 v131, v131
    ds_read_b128 v[190:193], v6 offset:20608
    v_exp_f32 v132, v132
    v_exp_f32 v133, v133
    v_smfmac_f32_32x32x32_bf16 v[48:63], v[204:207], v[120:127], v2
    v_exp_f32 v134, v134
    v_exp_f32 v135, v135
    ds_write_b128 v8, v[36:39] offset:1024
    v_exp_f32 v136, v136
    ds_read_b32 v194, v7 offset:21632
    v_exp_f32 v137, v137
    ds_write_b32 v9, v40 offset:2048
    v_exp_f32 v138, v138
    v_exp_f32 v139, v139
    v_exp_f32 v140, v140
    v_exp_f32 v141, v141
    v_exp_f32 v142, v142
    v_exp_f32 v143, v143
    v_exp_f32 v144, v144
    v_smfmac_f32_32x32x32_bf16 v[64:79], v[200:203], v[128:135], v2
    v_exp_f32 v145, v145
    v_exp_f32 v146, v146
    ds_write_b128 v8, v[48:51] offset:2176
    v_exp_f32 v147, v147
    ds_write_b128 v8, v[52:55] offset:3200
    v_exp_f32 v148, v148
    ds_write_b32 v9, v56 offset:4224
    v_exp_f32 v149, v149
    v_smfmac_f32_32x32x32_bf16 v[64:79], v[204:207], v[136:143], v2
    v_exp_f32 v150, v150
    v_exp_f32 v151, v151
    v_exp_f32 v152, v152
    s_waitcnt lgkmcnt(0)
    ds_write_b32 v242, v253 offset:144
    v_exp_f32 v153, v153
    v_exp_f32 v154, v154
    v_exp_f32 v155, v155
    s_mov_b32 s90, 0x400000
LW34:
    ds_read_b32 v12, v243 offset:144
    s_waitcnt lgkmcnt(0)
    v_cmp_eq_u32 vcc, 1, v12
    s_sub_u32 s90, s90, 1
    s_cbranch_scc1 LW34_out
    s_cmp_eq_u64 vcc, exec
    s_cbranch_scc0 LW34
LW34_out:
    ds_read_b128 v[96:99], v10 offset:0
    ds_read_b128 v[100:103], v10 offset:1024
    ds_read_b32 v104, v11 offset:2048
    v_exp_f32 v156, v156
    ds_read_b128 v[112:115], v10 offset:2176
    ds_read_b128 v[116:119], v10 offset:3200
    ds_read_b32 v120, v11 offset:4224
    v_exp_f32 v157, v157
    v_exp_f32 v158, v158
    v_exp_f32 v159, v159
    v_pk_add_f32 v[208:209], v[208:209], v[176:177]
    v_pk_add_f32 v[210:211], v[210:211], v[178:179]
    v_smfmac_f32_32x32x32_bf16 v[80:95], v[200:203], v[144:151], v2
    v_smfmac_f32_32x32x32_bf16 v[80:95], v[204:207], v[152:159], v2
    v_pk_add_f32 v[212:213], v[212:213], v[180:181]
    v_pk_add_f32 v[214:215], v[214:215], v[182:183]
    v_add_f32 v216, v216, v184
    v_pk_add_f32 v[64:65], v[64:65], v[208:209]
    v_pk_add_f32 v[66:67], v[66:67], v[210:211]
    v_pk_add_f32 v[68:69], v[68:69], v[212:213]
    v_pk_add_f32 v[70:71], v[70:71], v[214:215]
    v_add_f32 v72, v72, v216
    v_pk_add_f32 v[160:161], v[160:161], v[186:187]
    v_pk_add_f32 v[162:163], v[162:163], v[188:189]
    v_pk_add_f32 v[164:165], v[164:165], v[190:191]
    v_pk_add_f32 v[166:167], v[166:167], v[192:193]
    v_add_f32 v168, v168, v194
    s_waitcnt lgkmcnt(0)
    ds_write_b32 v242, v253 offset:96
    v_pk_add_f32 v[64:65], v[64:65], v[96:97]
    v_pk_add_f32 v[66:67], v[66:67], v[98:99]
    v_pk_add_f32 v[68:69], v[68:69], v[100:101]
    v_pk_add_f32 v[70:71], v[70:71], v[102:103]
    v_add_f32 v72, v72, v104
    v_pk_add_f32 v[160:161], v[160:161], v[112:113]
    v_pk_add_f32 v[162:163], v[162:163], v[114:115]
    v_pk_add_f32 v[164:165], v[164:165], v[116:117]
    v_pk_add_f32 v[166:167], v[166:167], v[118:119]
    v_add_f32 v168, v168, v120
    v_pk_add_f32 v[80:81], v[80:81], v[160:161]
    v_pk_add_f32 v[82:83], v[82:83], v[162:163]
    v_pk_add_f32 v[84:85], v[84:85], v[164:165]
    v_pk_add_f32 v[86:87], v[86:87], v[166:167]
    v_add_f32 v88, v88, v168
    v_mov_b32 v14, 0
    v_mov_b32 v15, 0
    v_pk_fma_f32 v[14:15], v[64:65], 0, v[14:15] op_sel_hi:[1,0,1]
    v_pk_fma_f32 v[14:15], v[66:67], 0, v[14:15] op_sel_hi:[1,0,1]
    v_pk_fma_f32 v[14:15], v[68:69], 0, v[14:15] op_sel_hi:[1,0,1]
    v_pk_fma_f32 v[14:15], v[70:71], 0, v[14:15] op_sel_hi:[1,0,1]
    v_pk_fma_f32 v[14:15], v[80:81], 0, v[14:15] op_sel_hi:[1,0,1]
    v_pk_fma_f32 v[14:15], v[82:83], 0, v[14:15] op_sel_hi:[1,0,1]
    v_pk_fma_f32 v[14:15], v[84:85], 0, v[14:15] op_sel_hi:[1,0,1]
    v_pk_fma_f32 v[14:15], v[86:87], 0, v[14:15] op_sel_hi:[1,0,1]
    v_add_f32 v14, v14, v15
    v_min_f32 v15, v72, v88
    v_add_f32 v14, v14, v72
    v_add_f32 v14, v14, v88
    v_cmp_lt_f32 vcc, 0x21800000, v15
    s_mov_b64 s[92:93], vcc
    v_cmp_gt_f32 vcc, 0x5d800000, v14
    s_and_b64 s[92:93], s[92:93], vcc
    s_cmp_eq_u64 s[92:93], exec
    s_cbranch_scc0 B_slow
B_fin:
    v_rcp_f32 v14, v72
    v_rcp_f32 v12, v88
    s_nop 0
    v_pk_mul_f32 v[64:65], v[64:65], v[14:15] op_sel_hi:[1,0]
    v_pk_mul_f32 v[66:67], v[66:67], v[14:15] op_sel_hi:[1,0]
    v_pk_mul_f32 v[68:69], v[68:69], v[14:15] op_sel_hi:[1,0]
    v_pk_mul_f32 v[70:71], v[70:71], v[14:15] op_sel_hi:[1,0]
    v_cvt_pk_bf16_f32 v208, v64, v65
    v_cvt_pk_bf16_f32 v209, v66, v67
    v_cvt_pk_bf16_f32 v210, v68, v69
    v_cvt_pk_bf16_f32 v211, v70, v71
    buffer_store_dwordx4 v[208:211], v3, s[32:35], s86 offen sc1
    v_pk_mul_f32 v[80:81], v[80:81], v[12:13] op_sel_hi:[1,0]
    v_pk_mul_f32 v[82:83], v[82:83], v[12:13] op_sel_hi:[1,0]
    v_pk_mul_f32 v[84:85], v[84:85], v[12:13] op_sel_hi:[1,0]
    v_pk_mul_f32 v[86:87], v[86:87], v[12:13] op_sel_hi:[1,0]
    v_cvt_pk_bf16_f32 v212, v80, v81
    v_cvt_pk_bf16_f32 v213, v82, v83
    v_cvt_pk_bf16_f32 v214, v84, v85
    v_cvt_pk_bf16_f32 v215, v86, v87
    buffer_store_dwordx4 v[212:215], v3, s[32:35], s87 offen sc1
    v_cmp_eq_u32 vcc, 1, v13
    s_nop 0
    s_cmp_eq_u64 vcc, exec
    s_cbranch_scc0 AS35
AS35_ok:
    s_mov_b32 s90, 0x400000
LW37:
    ds_read_b32 v12, v254 offset:160
    s_waitcnt lgkmcnt(0)
    v_cmp_eq_u32 vcc, 1, v12
    s_sub_u32 s90, s90, 1
    s_cbranch_scc1 LW37_out
    s_cmp_eq_u64 vcc, exec
    s_cbranch_scc0 LW37
LW37_out:
    v_xor_b32 v6, 4096, v232
    v_xor_b32 v7, 0x8000, v232
    v_xor_b32 v8, 0x9000, v232
    ds_read_b64_tr_b16 v[16:17], v232 offset:0
    ds_read_b64_tr_b16 v[18:19], v232 offset:512
    ds_read_b64_tr_b16 v[20:21], v232 offset:1024
    ds_read_b64_tr_b16 v[22:23], v232 offset:1536
    ds_read_b64_tr_b16 v[24:25], v232 offset:2048
    ds_read_b64_tr_b16 v[26:27], v232 offset:2560
    ds_read_b64_tr_b16 v[28:29], v232 offset:3072
    ds_read_b64_tr_b16 v[30:31], v232 offset:3584
    s_waitcnt lgkmcnt(4)
    ds_read_b64_tr_b16 v[32:33], v6 offset:0
    ds_read_b64_tr_b16 v[34:35], v6 offset:512
    ds_read_b64_tr_b16 v[36:37], v6 offset:1024
    ds_read_b64_tr_b16 v[38:39], v6 offset:1536
    ds_read_b64_tr_b16 v[40:41], v6 offset:2048
    ds_read_b64_tr_b16 v[42:43], v6 offset:2560
    ds_read_b64_tr_b16 v[44:45], v6 offset:3072
    ds_read_b64_tr_b16 v[46:47], v6 offset:3584
    s_waitcnt lgkmcnt(4)
    ds_read_b64_tr_b16 v[48:49], v7 offset:0
    ds_read_b64_tr_b16 v[50:51], v7 offset:512
    ds_read_b64_tr_b16 v[52:53], v7 offset:1024
    ds_read_b64_tr_b16 v[54:55], v7 offset:1536
    ds_read_b64_tr_b16 v[56:57], v7 offset:2048
    ds_read_b64_tr_b16 v[58:59], v7 offset:2560
    ds_read_b64_tr_b16 v[60:61], v7 offset:3072
    ds_read_b64_tr_b16 v[62:63], v7 offset:3584
    s_waitcnt lgkmcnt(4)
    ds_read_b64_tr_b16 v[64:65], v8 offset:0
    ds_read_b64_tr_b16 v[66:67], v8 offset:512
    ds_read_b64_tr_b16 v[68:69], v8 offset:1024
    ds_read_b64_tr_b16 v[70:71], v8 offset:1536
    ds_read_b64_tr_b16 v[72:73], v8 offset:2048
    ds_read_b64_tr_b16 v[74:75], v8 offset:2560
    ds_read_b64_tr_b16 v[76:77], v8 offset:3072
    ds_read_b64_tr_b16 v[78:79], v8 offset:3584
    s_mov_b32 s90, 0x400000
LW38:
    ds_read_b32 v12, v243 offset:96
    s_waitcnt lgkmcnt(0)
    v_cmp_eq_u32 vcc, 1, v12
    s_sub_u32 s90, s90, 1
    s_cbranch_scc1 LW38_out
    s_cmp_eq_u64 vcc, exec
    s_cbranch_scc0 LW38
LW38_out:
    ds_write_b32 v242, v253 offset:208
    buffer_load_dwordx4 v[80:83], v3, s[32:35], s67 offen offset:0 sc1
    buffer_load_dwordx4 v[84:87], v3, s[32:35], s67 offen offset:1024 sc1
    buffer_load_dwordx4 v[88:91], v3, s[32:35], s67 offen offset:2048 sc1
    buffer_load_dwordx4 v[92:95], v3, s[32:35], s67 offen offset:3072 sc1
    buffer_load_dwordx4 v[96:99], v3, s[32:35], s68 offen offset:0 sc1
    buffer_load_dwordx4 v[100:103], v3, s[32:35], s68 offen offset:1024 sc1
    buffer_load_dwordx4 v[104:107], v3, s[32:35], s68 offen offset:2048 sc1
    buffer_load_dwordx4 v[108:111], v3, s[32:35], s68 offen offset:3072 sc1
C_mm:
    s_waitcnt vmcnt(7)
    v_max3_u32 v6, v80, v81, v82
    v_max_u32 v6, v83, v6
    v_cmp_eq_u32 vcc, -1, v6
    s_nop 0
    s_cmp_eq_u64 vcc, 0
    s_cbranch_scc0 FR39
FR39_ok:
    v_mfma_f32_32x32x16_bf16 v[128:143], v[48:51], v[80:83], 0
    v_mfma_f32_32x32x16_bf16 v[112:127], v[16:19], v[80:83], 0
    s_waitcnt vmcnt(6)
    v_max3_u32 v6, v84, v85, v86
    v_max_u32 v6, v87, v6
    v_cmp_eq_u32 vcc, -1, v6
    s_nop 0
    s_cmp_eq_u64 vcc, 0
    s_cbranch_scc0 FR40
FR40_ok:
    v_mfma_f32_32x32x16_bf16 v[128:143], v[52:55], v[84:87], v[128:143]
    v_mfma_f32_32x32x16_bf16 v[112:127], v[20:23], v[84:87], v[112:127]
    s_waitcnt vmcnt(5)
    v_max3_u32 v6, v88, v89, v90
    v_max_u32 v6, v91, v6
    v_cmp_eq_u32 vcc, -1, v6
    s_nop 0
    s_cmp_eq_u64 vcc, 0
    s_cbranch_scc0 FR41
FR41_ok:
    v_mfma_f32_32x32x16_bf16 v[128:143], v[56:59], v[88:91], v[128:143]
    v_mfma_f32_32x32x16_bf16 v[112:127], v[24:27], v[88:91], v[112:127]
    s_waitcnt vmcnt(4)
    v_max3_u32 v6, v92, v93, v94
    v_max_u32 v6, v95, v6
    v_cmp_eq_u32 vcc, -1, v6
    s_nop 0
    s_cmp_eq_u64 vcc, 0
    s_cbranch_scc0 FR42
FR42_ok:
    v_mfma_f32_32x32x16_bf16 v[128:143], v[60:63], v[92:95], v[128:143]
    v_mfma_f32_32x32x16_bf16 v[112:127], v[28:31], v[92:95], v[112:127]
    s_waitcnt vmcnt(3)
    v_max3_u32 v6, v96, v97, v98
    v_max_u32 v6, v99, v6
    v_cmp_eq_u32 vcc, -1, v6
    s_nop 0
    s_cmp_eq_u64 vcc, 0
    s_cbranch_scc0 FR43
FR43_ok:
    v_mfma_f32_32x32x16_bf16 v[128:143], v[64:67], v[96:99], v[128:143]
    v_mfma_f32_32x32x16_bf16 v[112:127], v[32:35], v[96:99], v[112:127]
    s_waitcnt vmcnt(2)
    v_max3_u32 v6, v100, v101, v102
    v_max_u32 v6, v103, v6
    v_cmp_eq_u32 vcc, -1, v6
    s_nop 0
    s_cmp_eq_u64 vcc, 0
    s_cbranch_scc0 FR44
FR44_ok:
    v_mfma_f32_32x32x16_bf16 v[128:143], v[68:71], v[100:103], v[128:143]
    v_mfma_f32_32x32x16_bf16 v[112:127], v[36:39], v[100:103], v[112:127]
    s_waitcnt vmcnt(1)
    v_max3_u32 v6, v104, v105, v106
    v_max_u32 v6, v107, v6
    v_cmp_eq_u32 vcc, -1, v6
    s_nop 0
    s_cmp_eq_u64 vcc, 0
    s_cbranch_scc0 FR45
FR45_ok:
    v_mfma_f32_32x32x16_bf16 v[128:143], v[72:75], v[104:107], v[128:143]
    v_mfma_f32_32x32x16_bf16 v[112:127], v[40:43], v[104:107], v[112:127]
    s_waitcnt vmcnt(0)
    v_max3_u32 v6, v108, v109, v110
    v_max_u32 v6, v111, v6
    v_cmp_eq_u32 vcc, -1, v6
    s_nop 0
    s_cmp_eq_u64 vcc, 0
    s_cbranch_scc0 FR46
FR46_ok:
    v_mfma_f32_32x32x16_bf16 v[128:143], v[76:79], v[108:111], v[128:143]
    v_mfma_f32_32x32x16_bf16 v[112:127], v[44:47], v[108:111], v[112:127]
    s_nop 10
    ds_write_b128 v235, v[128:131]
    ds_write_b128 v235, v[132:135] offset:1024
    ds_write_b128 v236, v[136:139]
    ds_write_b128 v236, v[140:143] offset:1024
    ds_write_b128 v234, v[120:123]
    ds_write_b128 v234, v[124:127] offset:1024
    s_cmp_lt_u32 s30, 4
    s_waitcnt lgkmcnt(0)
    s_barrier
    s_cbranch_scc0 C_havexy
    ds_read_b128 v[144:147], v237
    ds_read_b128 v[148:151], v237 offset:1024
    ds_read_b32 v208, v238 offset:2048
C_havexy:
    ds_read_b128 v[80:83], v233 offset:0
    ds_read_b128 v[84:87], v233 offset:1024
    ds_read_b128 v[88:91], v233 offset:2048
    ds_read_b128 v[92:95], v233 offset:3072
    ds_read_b128 v[96:99], v233 offset:4096
    ds_read_b128 v[100:103], v233 offset:5120
    s_waitcnt lgkmcnt(4)
    v_pk_add_f32 v[112:113], v[112:113], v[80:81]
    v_pk_add_f32 v[114:115], v[114:115], v[82:83]
    v_pk_add_f32 v[116:117], v[116:117], v[84:85]
    v_pk_add_f32 v[118:119], v[118:119], v[86:87]
    s_waitcnt lgkmcnt(2)
    v_pk_add_f32 v[112:113], v[112:113], v[88:89]
    v_pk_add_f32 v[114:115], v[114:115], v[90:91]
    v_pk_add_f32 v[116:117], v[116:117], v[92:93]
    v_pk_add_f32 v[118:119], v[118:119], v[94:95]
    s_waitcnt lgkmcnt(0)
    v_pk_add_f32 v[112:113], v[112:113], v[96:97]
    v_pk_add_f32 v[114:115], v[114:115], v[98:99]
    v_pk_add_f32 v[116:117], v[116:117], v[100:101]
    v_pk_add_f32 v[118:119], v[118:119], v[102:103]
    v_pk_fma_f32 v[112:113], v[112:113], v[208:209], v[144:145] op_sel_hi:[1,0,1]
    v_pk_fma_f32 v[114:115], v[114:115], v[208:209], v[146:147] op_sel_hi:[1,0,1]
    v_pk_fma_f32 v[116:117], v[116:117], v[208:209], v[148:149] op_sel_hi:[1,0,1]
    v_pk_fma_f32 v[118:119], v[118:119], v[208:209], v[150:151] op_sel_hi:[1,0,1]
    v_cvt_pk_bf16_f32 v104, v112, v113
    v_cvt_pk_bf16_f32 v105, v114, v115
    v_cvt_pk_bf16_f32 v106, v116, v117
    v_cvt_pk_bf16_f32 v107, v118, v119
    s_nop 0
    v_permlane32_swap_b32 v104, v106
    v_permlane32_swap_b32 v105, v107
    buffer_store_dwordx4 v[104:107], v239, s[40:43], s69 offen
    s_endpgm
B_slow:
    s_add_u32 s70, s66, 2097152
    s_add_u32 s71, s66, 4194304
    s_mov_b32 s84, 0
    v_mov_b32 v208, 0xff800000
    v_mov_b32 v209, 0xff800000
B_slow1:
    s_add_u32 s85, s70, s84
    buffer_load_dwordx4 v[160:163], v3, s[32:35], s85 offen offset:0 sc1
    s_waitcnt vmcnt(0)
    v_mfma_f32_32x32x16_bf16 v[96:111], v[160:163], v[24:27], 0
    v_mfma_f32_32x32x16_bf16 v[112:127], v[160:163], v[28:31], 0
    s_nop 11
    v_max3_f32 v208, v96, v97, v208
    v_max3_f32 v208, v98, v99, v208
    v_max3_f32 v208, v100, v101, v208
    v_max3_f32 v208, v102, v103, v208
    v_max3_f32 v208, v104, v105, v208
    v_max3_f32 v208, v106, v107, v208
    v_max3_f32 v208, v108, v109, v208
    v_max3_f32 v208, v110, v111, v208
    v_max3_f32 v209, v112, v113, v209
    v_max3_f32 v209, v114, v115, v209
    v_max3_f32 v209, v116, v117, v209
    v_max3_f32 v209, v118, v119, v209
    v_max3_f32 v209, v120, v121, v209
    v_max3_f32 v209, v122, v123, v209
    v_max3_f32 v209, v124, v125, v209
    v_max3_f32 v209, v126, v127, v209
    s_add_u32 s84, s84, 1024
    s_cmp_lt_u32 s84, 0x10000
    s_cbranch_scc1 B_slow1
    v_mov_b32 v210, v208
    v_mov_b32 v211, v209
    s_nop 1
    v_permlane32_swap_b32 v208, v210
    v_permlane32_swap_b32 v209, v211
    v_max_f32 v208, v208, v210
    v_max_f32 v209, v209, v211
    s_mov_b32 s84, 0
    v_sub_f32 v128, 0, v208
    v_mov_b32 v64, 0
    v_sub_f32 v129, 0, v208
    v_mov_b32 v65, 0
    v_sub_f32 v130, 0, v208
    v_mov_b32 v66, 0
    v_sub_f32 v131, 0, v208
    v_mov_b32 v67, 0
    v_sub_f32 v132, 0, v208
    v_mov_b32 v68, 0
    v_sub_f32 v133, 0, v208
    v_mov_b32 v69, 0
    v_sub_f32 v134, 0, v208
    v_mov_b32 v70, 0
    v_sub_f32 v135, 0, v208
    v_mov_b32 v71, 0
    v_sub_f32 v136, 0, v208
    v_mov_b32 v72, 0
    v_sub_f32 v137, 0, v208
    v_mov_b32 v73, 0
    v_sub_f32 v138, 0, v208
    v_mov_b32 v74, 0
    v_sub_f32 v139, 0, v208
    v_mov_b32 v75, 0
    v_sub_f32 v140, 0, v208
    v_mov_b32 v76, 0
    v_sub_f32 v141, 0, v208
    v_mov_b32 v77, 0
    v_sub_f32 v142, 0, v208
    v_mov_b32 v78, 0
    v_sub_f32 v143, 0, v208
    v_mov_b32 v79, 0
    v_sub_f32 v144, 0, v209
    v_mov_b32 v80, 0
    v_sub_f32 v145, 0, v209
    v_mov_b32 v81, 0
    v_sub_f32 v146, 0, v209
    v_mov_b32 v82, 0
    v_sub_f32 v147, 0, v209
    v_mov_b32 v83, 0
    v_sub_f32 v148, 0, v209
    v_mov_b32 v84, 0
    v_sub_f32 v149, 0, v209
    v_mov_b32 v85, 0
    v_sub_f32 v150, 0, v209
    v_mov_b32 v86, 0
    v_sub_f32 v151, 0, v209
    v_mov_b32 v87, 0
    v_sub_f32 v152, 0, v209
    v_mov_b32 v88, 0
    v_sub_f32 v153, 0, v209
    v_mov_b32 v89, 0
    v_sub_f32 v154, 0, v209
    v_mov_b32 v90, 0
    v_sub_f32 v155, 0, v209
    v_mov_b32 v91, 0
    v_sub_f32 v156, 0, v209
    v_mov_b32 v92, 0
    v_sub_f32 v157, 0, v209
    v_mov_b32 v93, 0
    v_sub_f32 v158, 0, v209
    v_mov_b32 v94, 0
    v_sub_f32 v159, 0, v209
    v_mov_b32 v95, 0
    v_mov_b32 v176, 0x3f803f80
    v_mov_b32 v177, 0x3f803f80
    v_mov_b32 v178, 0x3f803f80
    v_mov_b32 v179, 0x3f803f80
    v_mov_b32 v180, 0x3f803f80
    v_mov_b32 v181, 0x3f803f80
    v_mov_b32 v182, 0x3f803f80
    v_mov_b32 v183, 0x3f803f80
B_slow2:
    s_add_u32 s85, s70, s84
    s_add_u32 s89, s71, s84
    buffer_load_dwordx4 v[160:163], v3, s[32:35], s85 offen offset:0 sc1
    s_mov_b64 exec, s[72:73]
    buffer_load_dwordx4 v[176:179], v4, s[32:35], s89 offen offset:0 sc1
    buffer_load_dwordx4 v[180:183], v4, s[32:35], s89 offen offset:512 sc1
    s_mov_b64 exec, -1
    s_waitcnt vmcnt(0)
    v_mfma_f32_32x32x16_bf16 v[96:111], v[160:163], v[24:27], v[128:143]
    v_mfma_f32_32x32x16_bf16 v[112:127], v[160:163], v[28:31], v[144:159]
    s_nop 11
    v_exp_f32 v96, v96
    v_exp_f32 v97, v97
    v_exp_f32 v98, v98
    v_exp_f32 v99, v99
    v_exp_f32 v100, v100
    v_exp_f32 v101, v101
    v_exp_f32 v102, v102
    v_exp_f32 v103, v103
    v_exp_f32 v104, v104
    v_exp_f32 v105, v105
    v_exp_f32 v106, v106
    v_exp_f32 v107, v107
    v_exp_f32 v108, v108
    v_exp_f32 v109, v109
    v_exp_f32 v110, v110
    v_exp_f32 v111, v111
    v_exp_f32 v112, v112
    v_exp_f32 v113, v113
    v_exp_f32 v114, v114
    v_exp_f32 v115, v115
    v_exp_f32 v116, v116
    v_exp_f32 v117, v117
    v_exp_f32 v118, v118
    v_exp_f32 v119, v119
    v_exp_f32 v120, v120
    v_exp_f32 v121, v121
    v_exp_f32 v122, v122
    v_exp_f32 v123, v123
    v_exp_f32 v124, v124
    v_exp_f32 v125, v125
    v_exp_f32 v126, v126
    v_exp_f32 v127, v127
    s_nop 1
    v_smfmac_f32_32x32x32_bf16 v[64:79], v[176:179], v[96:103], v2
    v_smfmac_f32_32x32x32_bf16 v[64:79], v[180:183], v[104:111], v2
    v_smfmac_f32_32x32x32_bf16 v[80:95], v[176:179], v[112:119], v2
    v_smfmac_f32_32x32x32_bf16 v[80:95], v[180:183], v[120:127], v2
    s_add_u32 s84, s84, 1024
    s_cmp_lt_u32 s84, 0x10000
    s_cbranch_scc1 B_slow2
    s_nop 11
    s_branch B_fin
AS1:
    s_mov_b32 s90, 40000
POLL2:
    buffer_load_dword v56, v29, s[52:55], 0 offen sc1
    s_waitcnt vmcnt(0)
    v_cmp_eq_u32 vcc, 1, v56
    s_sub_u32 s90, s90, 1
    s_cbranch_scc1 POLL2_out
    s_cmp_eq_u64 vcc, exec
    s_cbranch_scc0 POLL2
POLL2_out:
    s_branch AS1_ok
AS4:
    s_mov_b32 s90, 40000
POLL5:
    buffer_load_dword v57, v222, s[32:35], s74 offen sc1
    s_waitcnt vmcnt(0)
    v_cmp_eq_u32 vcc, 1, v57
    s_sub_u32 s90, s90, 1
    s_cbranch_scc1 POLL5_out
    s_cmp_eq_u64 vcc, exec
    s_cbranch_scc0 POLL5
POLL5_out:
    s_branch AS4_ok
AS8:
    s_mov_b32 s90, 40000
POLL9:
    buffer_load_dword v19, v228, s[52:55], 0 offen sc1
    s_waitcnt vmcnt(0)
    v_cmp_eq_u32 vcc, 1, v19
    s_sub_u32 s90, s90, 1
    s_cbranch_scc1 POLL9_out
    s_cmp_eq_u64 vcc, exec
    s_cbranch_scc0 POLL9
POLL9_out:
    s_branch AS8_ok
AS11:
    s_mov_b32 s90, 40000
POLL12:
    buffer_load_dword v12, v222, s[32:35], s74 offen sc1
    s_waitcnt vmcnt(0)
    v_cmp_eq_u32 vcc, 1, v12
    s_sub_u32 s90, s90, 1
    s_cbranch_scc1 POLL12_out
    s_cmp_eq_u64 vcc, exec
    s_cbranch_scc0 POLL12
POLL12_out:
    s_branch AS11_ok
AS14:
    s_mov_b32 s90, 40000
POLL15:
    buffer_load_dword v247, v241, s[32:35], s74 offen sc1
    s_waitcnt vmcnt(0)
    v_cmp_eq_u32 vcc, 1, v247
    s_sub_u32 s90, s90, 1
    s_cbranch_scc1 POLL15_out
    s_cmp_eq_u64 vcc, exec
    s_cbranch_scc0 POLL15
POLL15_out:
    s_branch AS14_ok
AS18:
    s_mov_b32 s90, 40000
POLL19:
    buffer_load_dword v212, v210, s[32:35], s87 offen sc1
    s_waitcnt vmcnt(0)
    v_cmp_eq_u32 vcc, 1, v212
    s_sub_u32 s90, s90, 1
    s_cbranch_scc1 POLL19_out
    s_cmp_eq_u64 vcc, exec
    s_cbranch_scc0 POLL19
POLL19_out:
    s_branch AS18_ok
AS20:
    s_mov_b32 s90, 40000
POLL21:
    buffer_load_dword v213, v211, s[32:35], s86 offen sc1
    s_waitcnt vmcnt(0)
    v_cmp_eq_u32 vcc, 1, v213
    s_sub_u32 s90, s90, 1
    s_cbranch_scc1 POLL21_out
    s_cmp_eq_u64 vcc, exec
    s_cbranch_scc0 POLL21
POLL21_out:
    s_branch AS20_ok
AS24:
    s_mov_b32 s90, 40000
POLL25:
    buffer_load_dword v212, v210, s[32:35], s17 offen sc1
    s_waitcnt vmcnt(0)
    v_cmp_eq_u32 vcc, 1, v212
    s_sub_u32 s90, s90, 1
    s_cbranch_scc1 POLL25_out
    s_cmp_eq_u64 vcc, exec
    s_cbranch_scc0 POLL25
POLL25_out:
    s_branch AS24_ok
AS26:
    s_mov_b32 s90, 40000
POLL27:
    buffer_load_dword v213, v240, s[32:35], s101 offen sc1
    s_waitcnt vmcnt(0)
    v_cmp_eq_u32 vcc, 1, v213
    s_sub_u32 s90, s90, 1
    s_cbranch_scc1 POLL27_out
    s_cmp_eq_u64 vcc, exec
    s_cbranch_scc0 POLL27
POLL27_out:
    s_branch AS26_ok
FR29:
    s_mov_b32 s90, 40000
FR29_l:
    buffer_load_dwordx4 v[144:147], v214, s[32:35], s15 offen sc1
    buffer_load_dwordx4 v[148:151], v214, s[32:35], s16 offen sc1
    s_waitcnt vmcnt(0)
    v_max3_u32 v10, v144, v145, v146
    v_max3_u32 v10, v147, v148, v10
    v_max3_u32 v10, v149, v150, v10
    v_max_u32 v10, v151, v10
    v_cmp_eq_u32 vcc, -1, v10
    s_nop 0
    s_cmp_eq_u64 vcc, 0
    s_cbranch_scc1 FR29_ok
    s_sub_u32 s90, s90, 1
    s_cbranch_scc0 FR29_l
    s_branch FR29_ok
AS35:
    s_mov_b32 s90, 40000
POLL36:
    buffer_load_dword v13, v240, s[32:35], s101 offen sc1
    s_waitcnt vmcnt(0)
    v_cmp_eq_u32 vcc, 1, v13
    s_sub_u32 s90, s90, 1
    s_cbranch_scc1 POLL36_out
    s_cmp_eq_u64 vcc, exec
    s_cbranch_scc0 POLL36
POLL36_out:
    s_branch AS35_ok
FR39:
    s_mov_b32 s90, 40000
FR39_l:
    buffer_load_dwordx4 v[80:83], v3, s[32:35], s67 offen offset:0 sc1
    buffer_load_dwordx4 v[84:87], v3, s[32:35], s67 offen offset:1024 sc1
    buffer_load_dwordx4 v[88:91], v3, s[32:35], s67 offen offset:2048 sc1
    buffer_load_dwordx4 v[92:95], v3, s[32:35], s67 offen offset:3072 sc1
    buffer_load_dwordx4 v[96:99], v3, s[32:35], s68 offen offset:0 sc1
    buffer_load_dwordx4 v[100:103], v3, s[32:35], s68 offen offset:1024 sc1
    buffer_load_dwordx4 v[104:107], v3, s[32:35], s68 offen offset:2048 sc1
    buffer_load_dwordx4 v[108:111], v3, s[32:35], s68 offen offset:3072 sc1
    s_waitcnt vmcnt(7)
    v_max3_u32 v6, v80, v81, v82
    v_max_u32 v6, v83, v6
    v_cmp_eq_u32 vcc, -1, v6
    s_nop 0
    s_cmp_eq_u64 vcc, 0
    s_cbranch_scc1 FR39_ok
    s_sub_u32 s90, s90, 1
    s_cbranch_scc0 FR39_l
    s_branch FR39_ok
FR40:
    s_mov_b32 s90, 40000
FR40_l:
    buffer_load_dwordx4 v[84:87], v3, s[32:35], s67 offen offset:1024 sc1
    buffer_load_dwordx4 v[88:91], v3, s[32:35], s67 offen offset:2048 sc1
    buffer_load_dwordx4 v[92:95], v3, s[32:35], s67 offen offset:3072 sc1
    buffer_load_dwordx4 v[96:99], v3, s[32:35], s68 offen offset:0 sc1
    buffer_load_dwordx4 v[100:103], v3, s[32:35], s68 offen offset:1024 sc1
    buffer_load_dwordx4 v[104:107], v3, s[32:35], s68 offen offset:2048 sc1
    buffer_load_dwordx4 v[108:111], v3, s[32:35], s68 offen offset:3072 sc1
    s_waitcnt vmcnt(6)
    v_max3_u32 v6, v84, v85, v86
    v_max_u32 v6, v87, v6
    v_cmp_eq_u32 vcc, -1, v6
    s_nop 0
    s_cmp_eq_u64 vcc, 0
    s_cbranch_scc1 FR40_ok
    s_sub_u32 s90, s90, 1
    s_cbranch_scc0 FR40_l
    s_branch FR40_ok
FR41:
    s_mov_b32 s90, 40000
FR41_l:
    buffer_load_dwordx4 v[88:91], v3, s[32:35], s67 offen offset:2048 sc1
    buffer_load_dwordx4 v[92:95], v3, s[32:35], s67 offen offset:3072 sc1
    buffer_load_dwordx4 v[96:99], v3, s[32:35], s68 offen offset:0 sc1
    buffer_load_dwordx4 v[100:103], v3, s[32:35], s68 offen offset:1024 sc1
    buffer_load_dwordx4 v[104:107], v3, s[32:35], s68 offen offset:2048 sc1
    buffer_load_dwordx4 v[108:111], v3, s[32:35], s68 offen offset:3072 sc1
    s_waitcnt vmcnt(5)
    v_max3_u32 v6, v88, v89, v90
    v_max_u32 v6, v91, v6
    v_cmp_eq_u32 vcc, -1, v6
    s_nop 0
    s_cmp_eq_u64 vcc, 0
    s_cbranch_scc1 FR41_ok
    s_sub_u32 s90, s90, 1
    s_cbranch_scc0 FR41_l
    s_branch FR41_ok
FR42:
    s_mov_b32 s90, 40000
FR42_l:
    buffer_load_dwordx4 v[92:95], v3, s[32:35], s67 offen offset:3072 sc1
    buffer_load_dwordx4 v[96:99], v3, s[32:35], s68 offen offset:0 sc1
    buffer_load_dwordx4 v[100:103], v3, s[32:35], s68 offen offset:1024 sc1
    buffer_load_dwordx4 v[104:107], v3, s[32:35], s68 offen offset:2048 sc1
    buffer_load_dwordx4 v[108:111], v3, s[32:35], s68 offen offset:3072 sc1
    s_waitcnt vmcnt(4)
    v_max3_u32 v6, v92, v93, v94
    v_max_u32 v6, v95, v6
    v_cmp_eq_u32 vcc, -1, v6
    s_nop 0
    s_cmp_eq_u64 vcc, 0
    s_cbranch_scc1 FR42_ok
    s_sub_u32 s90, s90, 1
    s_cbranch_scc0 FR42_l
    s_branch FR42_ok
FR43:
    s_mov_b32 s90, 40000
FR43_l:
    buffer_load_dwordx4 v[96:99], v3, s[32:35], s68 offen offset:0 sc1
    buffer_load_dwordx4 v[100:103], v3, s[32:35], s68 offen offset:1024 sc1
    buffer_load_dwordx4 v[104:107], v3, s[32:35], s68 offen offset:2048 sc1
    buffer_load_dwordx4 v[108:111], v3, s[32:35], s68 offen offset:3072 sc1
    s_waitcnt vmcnt(3)
    v_max3_u32 v6, v96, v97, v98
    v_max_u32 v6, v99, v6
    v_cmp_eq_u32 vcc, -1, v6
    s_nop 0
    s_cmp_eq_u64 vcc, 0
    s_cbranch_scc1 FR43_ok
    s_sub_u32 s90, s90, 1
    s_cbranch_scc0 FR43_l
    s_branch FR43_ok
FR44:
    s_mov_b32 s90, 40000
FR44_l:
    buffer_load_dwordx4 v[100:103], v3, s[32:35], s68 offen offset:1024 sc1
    buffer_load_dwordx4 v[104:107], v3, s[32:35], s68 offen offset:2048 sc1
    buffer_load_dwordx4 v[108:111], v3, s[32:35], s68 offen offset:3072 sc1
    s_waitcnt vmcnt(2)
    v_max3_u32 v6, v100, v101, v102
    v_max_u32 v6, v103, v6
    v_cmp_eq_u32 vcc, -1, v6
    s_nop 0
    s_cmp_eq_u64 vcc, 0
    s_cbranch_scc1 FR44_ok
    s_sub_u32 s90, s90, 1
    s_cbranch_scc0 FR44_l
    s_branch FR44_ok
FR45:
    s_mov_b32 s90, 40000
FR45_l:
    buffer_load_dwordx4 v[104:107], v3, s[32:35], s68 offen offset:2048 sc1
    buffer_load_dwordx4 v[108:111], v3, s[32:35], s68 offen offset:3072 sc1
    s_waitcnt vmcnt(1)
    v_max3_u32 v6, v104, v105, v106
    v_max_u32 v6, v107, v6
    v_cmp_eq_u32 vcc, -1, v6
    s_nop 0
    s_cmp_eq_u64 vcc, 0
    s_cbranch_scc1 FR45_ok
    s_sub_u32 s90, s90, 1
    s_cbranch_scc0 FR45_l
    s_branch FR45_ok
FR46:
    s_mov_b32 s90, 40000
FR46_l:
    buffer_load_dwordx4 v[108:111], v3, s[32:35], s68 offen offset:3072 sc1
    s_waitcnt vmcnt(0)
    v_max3_u32 v6, v108, v109, v110
    v_max_u32 v6, v111, v6
    v_cmp_eq_u32 vcc, -1, v6
    s_nop 0
    s_cmp_eq_u64 vcc, 0
    s_cbranch_scc1 FR46_ok
    s_sub_u32 s90, s90, 1
    s_cbranch_scc0 FR46_l
    s_branch FR46_ok
K_end:
    s_endpgm
.section .rodata,"a"
.p2align 6
.amdhsa_kernel gated_mix__mha_block__ssm_conv_h3__prompt_kernel
  .amdhsa_next_free_vgpr 256
  .amdhsa_next_free_sgpr 102
  .amdhsa_accum_offset 256
  .amdhsa_group_segment_fixed_size 0
  .amdhsa_kernarg_size 104
  .amdhsa_user_sgpr_count 2
  .amdhsa_user_sgpr_kernarg_segment_ptr 1
  .amdhsa_system_sgpr_workgroup_id_x 1
  .amdhsa_float_denorm_mode_32 3
.end_amdhsa_kernel
```
